```python
import torch

def _softmax(x, axis=-1):
    return torch.softmax(x, dim=axis)
def _gelu(x):
    return torch.nn.functional.gelu(x, approximate="tanh")
def _silu(x):
    return torch.nn.functional.silu(x)
def _sigmoid(x):
    return torch.sigmoid(x)
def _layernorm(x, axis=-1, eps=1e-5):
    m = x.mean(dim=axis, keepdim=True)
    v = x.var(dim=axis, keepdim=True, unbiased=False)
    return (x - m) / torch.sqrt(v + eps)
def _scatter_add(tgt, idx, src, axis=0):
    return tgt.clone().index_add_(axis, idx, src)
def _segment_sum(src, seg, n):
    out = torch.zeros((n,) + src.shape[1:], dtype=src.dtype)
    return out.index_add_(0, seg, src)
def _pad(x, pw):
    flat = tuple(v for pair in reversed(pw) for v in pair)
    return torch.nn.functional.pad(x, flat)

kernel_name = 'sequential_preLN__gqa_block_cached__glu_gated_glu__decode'

def setup_inputs():

    _w = (lambda a: (lambda t: t.to(torch.bfloat16) if t.is_floating_point() else t)(torch.as_tensor(a)))
    def _A_setup():
        B, Sq, D = 1, 1, 512
        Hq, Hkv, Sk, Dh = 32, 8, 32768, 128
        assert Hq % Hkv == 0, (Hq, Hkv)
        return {
            "x": _w((lambda *s: torch.randn(*s, dtype=torch.bfloat16) * 0.05)(B, Sq, D)),
            "k_cache": _w((lambda *s: torch.randn(*s, dtype=torch.bfloat16) * 3.2)(B, Hkv, Sk, Dh)),
            "v_cache": _w((lambda *s: torch.randn(*s, dtype=torch.bfloat16) * 0.4)(B, Hkv, Sk, Dh)),
            "wq": _w((lambda *s: torch.randn(*s, dtype=torch.bfloat16) * 3.2)(D, Hq * Dh) * (D ** -0.5)),
            "wo": _w((lambda *s: torch.randn(*s, dtype=torch.bfloat16) * 0.4)(Hq * Dh, D) * ((Hq * Dh) ** -0.5)),
        }
    _A_in = _A_setup()

    def _B_setup():
        B, S, D, F = 1, 1, 512, 1792
        return {
            "x": _w((lambda *s: torch.randn(*s, dtype=torch.bfloat16) * 0.05)(B, S, D)),
            "w_gate": _w((lambda *s: torch.randn(*s, dtype=torch.bfloat16) * 0.05)(D, F)),
            "w_up": _w((lambda *s: torch.randn(*s, dtype=torch.bfloat16) * 0.05)(D, F)),
            "w_down": _w((lambda *s: torch.randn(*s, dtype=torch.bfloat16) * 0.05)(F, D)),
        }
    _B_in = _B_setup()

    return {
        "A_x": _A_in["x"],
        "A_k_cache": _A_in["k_cache"],
        "A_v_cache": _A_in["v_cache"],
        "A_wq": _A_in["wq"],
        "A_wo": _A_in["wo"],
        "B_x": _B_in["x"],
        "B_w_gate": _B_in["w_gate"],
        "B_w_up": _B_in["w_up"],
        "B_w_down": _B_in["w_down"],
    }

def reference(A_x, A_k_cache, A_v_cache, A_wq, A_wo, B_x, B_w_gate, B_w_up, B_w_down):
    def _A_ref(x, k_cache, v_cache, wq, wo):
        B, Sq, D = x.shape
        Hq, Dh = 32, 128
        Hkv = k_cache.shape[1]
        rep = Hq // Hkv
        q = (lambda x, *d: x.permute(*d))((x @ wq).reshape(B, Sq, Hq, Dh), 0, 2, 1, 3)
        k = (lambda x, n, axis: torch.repeat_interleave(x, n, dim=axis))(k_cache, rep, axis=1)
        v = (lambda x, n, axis: torch.repeat_interleave(x, n, dim=axis))(v_cache, rep, axis=1)
        scores = torch.einsum("bhqd,bhkd->bhqk", q, k) * (Dh ** -0.5)
        p = _softmax(scores, axis=-1)
        o = torch.einsum("bhqk,bhkd->bhqd", p, v)
        return (lambda x, *d: x.permute(*d))(o, 0, 2, 1, 3).reshape(B, Sq, Hq * Dh) @ wo

    def _B_ref(x, w_gate, w_up, w_down):
        g = torch.einsum("bsd,df->bsf", x, w_gate)
        u = torch.einsum("bsd,df->bsf", x, w_up)
        h = _sigmoid(g) * u
        return torch.einsum("bsf,fd->bsd", h, w_down)

    x = A_x
    h = x + _A_ref(_layernorm(x, axis=-1), A_k_cache, A_v_cache, A_wq, A_wo)
    h2 = h + _B_ref(_layernorm(h, axis=-1), B_w_gate, B_w_up, B_w_down)
    return h2
```

```asm
; @launch grid=(256,1,1) block=(256,1,1) lds=63488
.amdgcn_target "amdgcn-amd-amdhsa--gfx950"
.text
.globl sequential_preLN__gqa_block_cached__glu_gated_glu__decode_kernel
.p2align 8
.type sequential_preLN__gqa_block_cached__glu_gated_glu__decode_kernel,@function
sequential_preLN__gqa_block_cached__glu_gated_glu__decode_kernel:
  s_lshr_b32 s5, s2, 3
  s_cmp_ge_u32 s5, 32
  s_cbranch_scc1 L_end
  s_load_dwordx2 s[8:9], s[0:1], 8
  s_load_dwordx2 s[24:25], s[0:1], 24
  v_lshrrev_b32 v6, 6, v0
  s_and_b32 s4, s2, 7
  s_lshl_b32 s74, s4, 23
  s_lshl_b32 s6, s5, 14
  s_add_u32 s74, s74, s6
  v_and_b32 v7, 15, v0
  v_bfe_u32 v8, v0, 4, 2
  v_lshlrev_b32 v178, 6, v7
  v_lshl_add_u32 v178, v8, 4, v178
  s_brev_b32 s10, 32
  s_mov_b32 s11, 0x20000
  v_readfirstlane_b32 s3, v6
  s_mov_b32 s27, s11
  s_lshr_b32 s26, s10, 4
  v_bfe_u32 v10, v0, 1, 3
  v_and_b32 v11, 1, v0
  v_lshlrev_b32 v12, 5, v8
  v_lshl_add_u32 v12, v11, 4, v12
  v_lshl_add_u32 v180, v10, 13, v12
  v_lshl_add_u32 v180, v6, 18, v180
  s_mul_i32 s62, s4, 0x1020
  s_and_b32 s62, s62, 0x6020
  s_add_u32 s62, s62, s5
  s_lshl_b32 s63, s62, 7
  s_lshl_b32 m0, s3, 12
  s_mov_b32 s62, 0xfc00
  s_add_u32 s74, s74, m0
  s_waitcnt lgkmcnt(0)
  buffer_load_dwordx4 v180, s[24:27], s63 offen offset:0 nt lds
  s_add_u32 s63, s63, s62
  buffer_load_dwordx4 v180, s[24:27], s63 offen offset:1024 nt lds
  buffer_load_dwordx4 a[0:3], v178, s[8:11], s74 offen offset:0 nt
  buffer_load_dwordx4 a[4:7], v178, s[8:11], s74 offen offset:1024 nt
  s_add_u32 s63, s63, s62
  buffer_load_dwordx4 v180, s[24:27], s63 offen offset:2048 nt lds
  buffer_load_dwordx4 a[8:11], v178, s[8:11], s74 offen offset:2048 nt
  buffer_load_dwordx4 a[12:15], v178, s[8:11], s74 offen offset:3072 nt
  s_add_u32 s63, s63, s62
  buffer_load_dwordx4 v180, s[24:27], s63 offen offset:3072 nt lds
  s_load_dwordx2 s[12:13], s[0:1], 16
  s_load_dwordx2 s[20:21], s[0:1], 0
  s_load_dwordx2 s[16:17], s[0:1], 88
  s_load_dwordx2 s[44:45], s[0:1], 80
  s_load_dwordx2 s[48:49], s[0:1], 32
  s_load_dwordx2 s[50:51], s[0:1], 48
  s_load_dwordx2 s[52:53], s[0:1], 56
  s_load_dwordx2 s[36:37], s[0:1], 64
  s_load_dwordx2 s[40:41], s[0:1], 72
  v_and_b32 v1, 63, v0
  v_readfirstlane_b32 s3, v6
  v_lshlrev_b32 v3, 4, v1
  s_mov_b32 s14, 0x4000000
  s_mov_b32 s15, 0x20000
  s_mov_b32 s22, 0x400
  s_mov_b32 s23, 0x20000
  s_mov_b32 s26, 0x400000
  s_mov_b32 s27, 0x20000
  s_mov_b32 s18, 0x100000
  s_mov_b32 s19, 0x20000
  s_mov_b32 s46, 0x100
  s_mov_b32 s47, 0x20000
  s_mov_b32 s38, 0x1c0000
  s_mov_b32 s39, 0x20000
  s_mov_b32 s42, 0x400
  s_mov_b32 s43, 0x20000
  v_and_b32 v9, 31, v1
  s_lshl_b32 s62, s3, 8
  v_lshl_add_u32 v179, v9, 3, s62
  v_bfe_u32 v10, v1, 1, 3
  v_and_b32 v11, 1, v1
  v_lshlrev_b32 v12, 5, v8
  v_lshl_add_u32 v12, v11, 4, v12
  s_lshr_b32 s64, s5, 3
  s_and_b32 s65, s5, 7
  s_add_u32 s73, s5, 0
  s_and_b32 s73, s73, 7
  s_lshr_b32 s72, s4, 1
  s_lshl_b32 s62, s72, 2
  s_add_u32 s62, s62, s3
  s_lshl_b32 s62, s62, 18
  s_and_b32 s63, s4, 1
  s_lshl_b32 s63, s63, 2
  s_add_u32 s63, s63, s64
  s_lshl_b32 s63, s63, 10
  s_add_u32 s62, s62, s63
  s_lshl_b32 s63, s73, 7
  s_add_u32 s62, s62, s63
  v_lshl_add_u32 v180, v10, 13, v12
  v_add_u32 v180, s62, v180
  s_waitcnt lgkmcnt(0)
  v_mov_b32 v198, -1
  v_mov_b32 v199, -1
  v_mov_b32 v200, -1
  v_mov_b32 v201, -1
  s_cmp_ge_u32 s5, 28
  s_cselect_b32 s71, 2, 1
  s_and_b32 s62, s4, 1
  s_cmp_eq_u32 s62, 0
  s_cselect_b32 s71, 0, s71
  s_lshl_b32 s62, s4, 5
  s_add_u32 s62, s62, s5
  s_lshl_b32 s62, s62, 11
  s_lshl_b32 s63, s3, 9
  s_add_u32 s62, s62, s63
  s_add_u32 s62, s62, 0x80000
  v_lshl_add_u32 v186, v9, 4, s62
  s_mov_b32 s31, 0x20000
  s_mov_b32 s35, 0x20000
  s_cmp_eq_u32 s71, 2
  s_cbranch_scc1 L_setD_2
  s_cmp_eq_u32 s71, 1
  s_cbranch_scc1 L_setC_1
  s_lshr_b32 s62, s4, 1
  s_lshl_b32 s62, s62, 2
  s_add_u32 s66, s62, s64
  s_mov_b64 s[28:29], s[48:49]
  s_mov_b32 s30, 0x400000
  s_mov_b64 s[32:33], s[48:49]
  s_mov_b32 s34, 0x400000
  s_mov_b32 s69, 8192
  s_mov_b32 s70, 32768
  s_lshl_b32 s62, s66, 18
  s_lshl_b32 s63, s3, 16
  s_add_u32 s62, s62, s63
  s_lshl_b32 s63, s65, 7
  s_add_u32 s62, s62, s63
  v_lshl_add_u32 v183, v10, 10, v12
  v_add_u32 v183, s62, v183
  s_lshl_b32 s62, s66, 11
  s_lshl_b32 s63, s65, 8
  s_add_u32 s62, s62, s63
  s_lshl_b32 s63, s3, 6
  s_add_u32 s62, s62, s63
  s_add_u32 s62, s62, 0x4000
  v_lshl_add_u32 v13, v9, 4, s62
  v_cmp_gt_u32 vcc, 4, v9
  v_mov_b32 v14, 0x20000000
  s_nop 0
  v_cndmask_b32 v13, v14, v13, vcc
  s_branch L_setJ_3
L_setC_1:
  s_lshr_b32 s62, s4, 1
  s_mul_i32 s66, s62, 28
  s_add_u32 s66, s66, s5
  s_mov_b64 s[28:29], s[50:51]
  s_mov_b64 s[32:33], s[52:53]
  s_mov_b32 s30, 1835008
  s_mov_b32 s34, 1835008
  s_mov_b32 s69, 114688
  s_mov_b32 s70, 0
  v_lshrrev_b32 v13, 1, v1
  v_mul_u32_u24 v13, 3584, v13
  v_lshl_add_u32 v13, v11, 4, v13
  s_mul_i32 s62, s3, 458752
  s_lshl_b32 s63, s66, 5
  s_add_u32 s62, s62, s63
  v_add_u32 v183, s62, v13
  s_lshl_b32 s62, s66, 11
  s_lshl_b32 s63, s3, 9
  s_add_u32 s62, s62, s63
  s_add_u32 s62, s62, 0x20000
  v_lshl_add_u32 v13, v9, 4, s62
  s_branch L_setJ_3
L_setD_2:
  s_lshr_b32 s62, s4, 1
  s_lshl_b32 s66, s62, 2
  s_add_u32 s66, s66, s5
  s_sub_u32 s66, s66, 28
  s_mov_b64 s[28:29], s[48:49]
  s_mov_b32 s30, 0
  s_mov_b64 s[32:33], s[48:49]
  s_mov_b32 s34, 0
  s_mov_b32 s69, 0
  s_mov_b32 s70, 0
  v_mov_b32 v183, 0
  v_mov_b32 v13, 0x20000000
L_setJ_3:
  v_cmp_gt_u32 vcc, 32, v1
  s_and_b32 s62, s4, 1
  s_lshl_b32 s62, s62, 2
  s_add_u32 s62, s62, s64
  s_lshl_b32 s62, s62, 2
  s_add_u32 s62, s62, s72
  s_lshl_b32 s62, s62, 3
  s_add_u32 s62, s62, s73
  s_lshl_b32 s62, s62, 8
  s_add_u32 s62, s62, 0x10000
  v_cndmask_b32 v13, v13, v186, vcc
  buffer_store_dwordx4 v[198:201], v13, s[16:19], 0 offen sc1
  v_lshl_add_u32 v187, v1, 2, s62
  s_lshl_b32 s63, s3, 6
  s_add_u32 s62, s62, s63
  v_lshl_add_u32 v14, v1, 4, s62
  s_lshl_b32 s62, s4, 5
  s_add_u32 s62, s62, s5
  s_lshl_b32 s62, s62, 7
  s_add_u32 s62, s62, 393152
  s_cmp_eq_u32 s3, 0
  s_cselect_b32 s62, s62, 0x20000000
  v_lshl_add_u32 v15, v1, 4, s62
  v_cmp_gt_u32 vcc, 4, v1
  s_nop 1
  v_cndmask_b32 v14, v15, v14, vcc
  s_mov_b64 exec, 63
  buffer_store_dwordx4 v[198:201], v14, s[16:19], 0 offen sc1
  s_mov_b64 exec, -1
  s_add_u32 s6, s74, 0x80000
  buffer_load_dwordx4 a[16:19], v178, s[8:11], s6 offen offset:0 nt
  buffer_load_dwordx4 a[20:23], v178, s[8:11], s6 offen offset:1024 nt
  buffer_load_dwordx2 v[202:203], v179, s[20:23], 0 offen
  v_lshlrev_b32 v6, 4, v1
  buffer_load_dwordx4 v[212:215], v6, s[20:23], 0 offen
  s_lshl_b32 s62, s72, 2
  s_add_u32 s62, s62, s3
  s_lshl_b32 s62, s62, 6
  v_lshl_add_u32 v6, v8, 3, s62
  buffer_load_dwordx2 v[216:217], v6, s[20:23], 0 offen
  buffer_load_dwordx2 v[218:219], v6, s[20:23], 0 offen offset:32
  s_mov_b32 s67, 0x3fb8aa3b
  s_mov_b32 s68, 0x3db504f3
  v_and_b32 v6, 1, v1
  v_cmp_ne_u32 s[54:55], 0, v6
  v_and_b32 v6, 2, v1
  v_cmp_ne_u32 s[56:57], 0, v6
  v_and_b32 v6, 16, v1
  v_cmp_ne_u32 s[58:59], 0, v6
  v_and_b32 v6, 32, v1
  v_cmp_ne_u32 s[60:61], 0, v6
  v_mov_b32 v6, 0xffff
  v_mov_b32 v7, 0xffff0000
  v_cndmask_b32_e64 v6, v6, v7, s[54:55]
  v_cndmask_b32_e64 v4, v6, 0, s[56:57]
  v_cndmask_b32_e64 v5, 0, v6, s[56:57]
  v_mov_b32 v58, 0
  v_mov_b32 v59, 0
  v_mov_b32 v60, 0
  v_mov_b32 v61, 0
  v_mov_b32 v62, 0
  v_mov_b32 v63, 0
  v_mov_b32 v64, 0
  v_mov_b32 v65, 0
  buffer_load_dwordx4 a[24:27], v178, s[8:11], s6 offen offset:2048 nt
  s_waitcnt vmcnt(14)
  buffer_load_dwordx4 a[28:31], v178, s[8:11], s6 offen offset:3072 nt
  s_waitcnt vmcnt(14)
  s_add_u32 s6, s74, 0x100000
  buffer_load_dwordx4 a[32:35], v178, s[8:11], s6 offen offset:0 nt
  s_waitcnt vmcnt(13)
  buffer_load_dwordx4 a[36:39], v178, s[8:11], s6 offen offset:1024 nt
  s_waitcnt vmcnt(13)
  buffer_load_dwordx4 a[40:43], v178, s[8:11], s6 offen offset:2048 nt
  s_waitcnt vmcnt(10)
  buffer_load_dwordx4 a[44:47], v178, s[8:11], s6 offen offset:3072 nt
  s_waitcnt vmcnt(10)
  s_add_u32 s6, s74, 0x180000
  buffer_load_dwordx4 a[48:51], v178, s[8:11], s6 offen offset:0 nt
  s_waitcnt vmcnt(6)
  buffer_load_dwordx4 a[52:55], v178, s[8:11], s6 offen offset:1024 nt
  s_lshl_b32 s62, s3, 12
  v_lshrrev_b32 v6, 5, v1
  v_lshlrev_b32 v6, 10, v6
  v_and_b32 v7, 31, v1
  v_lshl_add_u32 v6, v7, 3, v6
  v_add_u32 v9, s62, v6
  ds_read_b64_tr_b16 v[90:91], v9 offset:0
  ds_read_b64_tr_b16 v[92:93], v9 offset:2048
  ds_read_b64_tr_b16 v[94:95], v9 offset:256
  ds_read_b64_tr_b16 v[96:97], v9 offset:2304
  ds_read_b64_tr_b16 v[98:99], v9 offset:512
  ds_read_b64_tr_b16 v[100:101], v9 offset:2560
  ds_read_b64_tr_b16 v[102:103], v9 offset:768
  ds_read_b64_tr_b16 v[104:105], v9 offset:2816
  v_lshlrev_b32 v18, 16, v202
  v_and_b32 v19, 0xffff0000, v202
  v_lshlrev_b32 v20, 16, v203
  v_and_b32 v21, 0xffff0000, v203
  v_lshlrev_b32 v42, 16, v212
  v_and_b32 v43, 0xffff0000, v212
  v_lshlrev_b32 v44, 16, v213
  v_and_b32 v45, 0xffff0000, v213
  v_lshlrev_b32 v46, 16, v214
  v_and_b32 v47, 0xffff0000, v214
  v_lshlrev_b32 v48, 16, v215
  v_and_b32 v49, 0xffff0000, v215
  v_pk_add_f32 v[50:51], v[42:43], v[44:45]
  v_pk_add_f32 v[52:53], v[46:47], v[48:49]
  v_pk_add_f32 v[50:51], v[50:51], v[52:53]
  v_add_f32 v6, v50, v51
  s_waitcnt vmcnt(6)
  buffer_load_dwordx4 a[56:59], v178, s[8:11], s6 offen offset:2048 nt
  s_nop 1
  v_add_f32_dpp v6, v6, v6 quad_perm:[1,0,3,2] row_mask:0xf bank_mask:0xf
  s_nop 1
  v_add_f32_dpp v6, v6, v6 quad_perm:[2,3,0,1] row_mask:0xf bank_mask:0xf
  s_nop 1
  v_add_f32_dpp v6, v6, v6 row_half_mirror row_mask:0xf bank_mask:0xf
  s_nop 1
  v_add_f32_dpp v6, v6, v6 row_mirror row_mask:0xf bank_mask:0xf
  v_mov_b32 v7, v6
  s_nop 1
  v_permlane16_swap_b32 v6, v7
  v_add_f32 v6, v6, v7
  v_mov_b32 v7, v6
  s_nop 1
  v_permlane32_swap_b32 v6, v7
  v_add_f32 v6, v6, v7
  v_mul_f32 v6, 0x3b000000, v6
  v_sub_f32 v42, v42, v6
  v_sub_f32 v43, v43, v6
  v_sub_f32 v44, v44, v6
  v_sub_f32 v45, v45, v6
  v_sub_f32 v46, v46, v6
  v_sub_f32 v47, v47, v6
  v_sub_f32 v48, v48, v6
  v_sub_f32 v49, v49, v6
  v_mul_f32 v8, v42, v42
  v_fmac_f32 v8, v43, v43
  v_fmac_f32 v8, v44, v44
  v_fmac_f32 v8, v45, v45
  v_fmac_f32 v8, v46, v46
  v_fmac_f32 v8, v47, v47
  v_fmac_f32 v8, v48, v48
  v_fmac_f32 v8, v49, v49
  s_waitcnt vmcnt(6)
  buffer_load_dwordx4 a[60:63], v178, s[8:11], s6 offen offset:3072 nt
  s_nop 1
  v_add_f32_dpp v8, v8, v8 quad_perm:[1,0,3,2] row_mask:0xf bank_mask:0xf
  s_nop 1
  v_add_f32_dpp v8, v8, v8 quad_perm:[2,3,0,1] row_mask:0xf bank_mask:0xf
  s_nop 1
  v_add_f32_dpp v8, v8, v8 row_half_mirror row_mask:0xf bank_mask:0xf
  s_nop 1
  v_add_f32_dpp v8, v8, v8 row_mirror row_mask:0xf bank_mask:0xf
  v_mov_b32 v7, v8
  s_nop 1
  v_permlane16_swap_b32 v8, v7
  v_add_f32 v8, v8, v7
  v_mov_b32 v7, v8
  s_nop 1
  v_permlane32_swap_b32 v8, v7
  v_add_f32 v8, v8, v7
  v_mul_f32 v8, 0x3b000000, v8
  v_cvt_pk_bf16_f32 v7, v6, v8
  v_lshlrev_b32 v6, 16, v7
  v_and_b32 v8, 0xffff0000, v7
  v_add_f32 v8, 0x3727c5ac, v8
  v_cvt_pk_bf16_f32 v8, v8, v8
  v_lshlrev_b32 v8, 16, v8
  v_sqrt_f32 v8, v8
  v_lshlrev_b32 v42, 16, v216
  v_and_b32 v43, 0xffff0000, v216
  v_lshlrev_b32 v44, 16, v217
  v_and_b32 v45, 0xffff0000, v217
  v_lshlrev_b32 v46, 16, v218
  v_and_b32 v47, 0xffff0000, v218
  v_lshlrev_b32 v48, 16, v219
  v_and_b32 v49, 0xffff0000, v219
  v_cvt_pk_bf16_f32 v8, v8, v8
  v_lshlrev_b32 v8, 16, v8
  v_rcp_f32 v8, v8
  s_waitcnt vmcnt(6)
  s_add_u32 s6, s74, 0x200000
  buffer_load_dwordx4 a[64:67], v178, s[8:11], s6 offen offset:0 nt
  v_sub_f32 v42, v42, v6
  v_sub_f32 v43, v43, v6
  v_sub_f32 v44, v44, v6
  v_sub_f32 v45, v45, v6
  v_sub_f32 v46, v46, v6
  v_sub_f32 v47, v47, v6
  v_sub_f32 v48, v48, v6
  v_sub_f32 v49, v49, v6
  v_cvt_pk_bf16_f32 v7, v42, v43
  v_lshlrev_b32 v42, 16, v7
  v_and_b32 v43, 0xffff0000, v7
  v_cvt_pk_bf16_f32 v7, v44, v45
  v_lshlrev_b32 v44, 16, v7
  v_and_b32 v45, 0xffff0000, v7
  v_cvt_pk_bf16_f32 v7, v46, v47
  v_lshlrev_b32 v46, 16, v7
  v_and_b32 v47, 0xffff0000, v7
  v_cvt_pk_bf16_f32 v7, v48, v49
  v_lshlrev_b32 v48, 16, v7
  v_and_b32 v49, 0xffff0000, v7
  v_mul_f32 v42, v42, v8
  v_mul_f32 v43, v43, v8
  v_mul_f32 v44, v44, v8
  v_mul_f32 v45, v45, v8
  v_mul_f32 v46, v46, v8
  v_mul_f32 v47, v47, v8
  v_mul_f32 v48, v48, v8
  v_mul_f32 v49, v49, v8
  v_cvt_pk_bf16_f32 v74, v42, v43
  v_cvt_pk_bf16_f32 v75, v44, v45
  v_cvt_pk_bf16_f32 v76, v46, v47
  v_cvt_pk_bf16_f32 v77, v48, v49
  s_lshl_b32 s62, s3, 2
  v_lshl_add_u32 v15, v1, 4, s62
  s_waitcnt lgkmcnt(0)
  v_mfma_f32_16x16x32_bf16 v[42:45], v[74:77], v[90:93], 0
  v_mfma_f32_16x16x32_bf16 v[46:49], v[74:77], v[94:97], 0
  v_mfma_f32_16x16x32_bf16 v[50:53], v[74:77], v[98:101], 0
  v_mfma_f32_16x16x32_bf16 v[54:57], v[74:77], v[102:105], 0
  s_waitcnt vmcnt(6)
  buffer_load_dwordx4 a[68:71], v178, s[8:11], s6 offen offset:1024 nt
  s_nop 7
  v_cndmask_b32_e64 v6, v42, v46, s[58:59]
  v_cndmask_b32_e64 v7, v50, v54, s[58:59]
  v_cndmask_b32_e64 v6, v6, v7, s[60:61]
  ds_write_b32 v15, v6 offset:52224
  v_mov_b32 v8, 0x3f803f80
  v_lshlrev_b32 v9, 2, v1
  ds_write_b32 v9, v8 offset:54272
  s_waitcnt vmcnt(6)
  buffer_load_dwordx4 a[72:75], v178, s[8:11], s6 offen offset:2048 nt
  s_waitcnt lgkmcnt(0)
  s_barrier
  s_cmp_lg_u32 s3, 3
  s_cbranch_scc1 L_nosig_4
  s_and_b32 s62, s2, 63
  s_lshl_b32 s62, s62, 2
  s_mov_b32 s7, 1
  s_atomic_add s7, s[44:45], s62
L_nosig_4:
  s_cmp_lg_u32 s3, 0
  s_cbranch_scc1 L_noq_5
  v_lshlrev_b32 v6, 4, v1
  ds_read_b128 v[42:45], v6 offset:52224
  s_mov_b32 s62, 0x2000
  s_waitcnt lgkmcnt(0)
  v_add_f32 v42, v42, v43
  v_add_f32 v44, v44, v45
  v_add_f32 v42, v42, v44
  buffer_store_dword v42, v187, s[16:19], 0 offen sc1
L_noq_5:
  s_waitcnt vmcnt(6)
  buffer_load_dwordx4 a[76:79], v178, s[8:11], s6 offen offset:3072 nt
  s_waitcnt vmcnt(6)
  s_add_u32 s6, s74, 0x280000
  buffer_load_dwordx4 a[80:83], v178, s[8:11], s6 offen offset:0 nt
  s_waitcnt vmcnt(6)
  buffer_load_dwordx4 a[84:87], v178, s[8:11], s6 offen offset:1024 nt
  s_waitcnt vmcnt(6)
  buffer_load_dwordx4 a[88:91], v178, s[8:11], s6 offen offset:2048 nt
  s_waitcnt vmcnt(6)
  buffer_load_dwordx4 a[92:95], v178, s[8:11], s6 offen offset:3072 nt
  s_waitcnt vmcnt(6)
  s_add_u32 s6, s74, 0x300000
  buffer_load_dwordx4 a[96:99], v178, s[8:11], s6 offen offset:0 nt
  s_waitcnt vmcnt(6)
  buffer_load_dwordx4 a[100:103], v178, s[8:11], s6 offen offset:1024 nt
  s_waitcnt vmcnt(6)
  buffer_load_dwordx4 a[104:107], v178, s[8:11], s6 offen offset:2048 nt
  s_waitcnt vmcnt(6)
  buffer_load_dwordx4 a[108:111], v178, s[8:11], s6 offen offset:3072 nt
  s_waitcnt vmcnt(6)
  s_add_u32 s6, s74, 0x380000
  buffer_load_dwordx4 a[112:115], v178, s[8:11], s6 offen offset:0 nt
  s_waitcnt vmcnt(6)
  buffer_load_dwordx4 a[116:119], v178, s[8:11], s6 offen offset:1024 nt
  s_waitcnt vmcnt(6)
  buffer_load_dwordx4 a[120:123], v178, s[8:11], s6 offen offset:2048 nt
  s_waitcnt vmcnt(6)
  buffer_load_dwordx4 a[124:127], v178, s[8:11], s6 offen offset:3072 nt
  s_waitcnt vmcnt(6)
  s_add_u32 s6, s74, 0x400000
  buffer_load_dwordx4 a[128:131], v178, s[8:11], s6 offen offset:0 nt
  s_waitcnt vmcnt(6)
  buffer_load_dwordx4 a[132:135], v178, s[8:11], s6 offen offset:1024 nt
  s_waitcnt vmcnt(6)
  buffer_load_dwordx4 a[136:139], v178, s[8:11], s6 offen offset:2048 nt
  s_waitcnt vmcnt(6)
  buffer_load_dwordx4 a[140:143], v178, s[8:11], s6 offen offset:3072 nt
  s_waitcnt vmcnt(6)
  s_add_u32 s6, s74, 0x480000
  buffer_load_dwordx4 a[144:147], v178, s[8:11], s6 offen offset:0 nt
  s_waitcnt vmcnt(6)
  buffer_load_dwordx4 a[148:151], v178, s[8:11], s6 offen offset:1024 nt
  s_waitcnt vmcnt(6)
  buffer_load_dwordx4 a[152:155], v178, s[8:11], s6 offen offset:2048 nt
  s_waitcnt vmcnt(6)
  buffer_load_dwordx4 a[156:159], v178, s[8:11], s6 offen offset:3072 nt
  s_waitcnt vmcnt(6)
  s_add_u32 s6, s74, 0x500000
  buffer_load_dwordx4 a[160:163], v178, s[8:11], s6 offen offset:0 nt
  s_waitcnt vmcnt(6)
  buffer_load_dwordx4 a[164:167], v178, s[8:11], s6 offen offset:1024 nt
  s_waitcnt vmcnt(6)
  buffer_load_dwordx4 a[168:171], v178, s[8:11], s6 offen offset:2048 nt
  s_waitcnt vmcnt(6)
  buffer_load_dwordx4 a[172:175], v178, s[8:11], s6 offen offset:3072 nt
  s_waitcnt vmcnt(6)
  s_add_u32 s6, s74, 0x580000
  buffer_load_dwordx4 a[176:179], v178, s[8:11], s6 offen offset:0 nt
  s_waitcnt vmcnt(6)
  buffer_load_dwordx4 a[180:183], v178, s[8:11], s6 offen offset:1024 nt
  s_waitcnt vmcnt(6)
  buffer_load_dwordx4 a[184:187], v178, s[8:11], s6 offen offset:2048 nt
  v_lshlrev_b32 v181, 2, v1
  buffer_load_dword v190, v181, s[44:47], 0 offen sc1
  s_waitcnt vmcnt(7)
  buffer_load_dwordx4 a[188:191], v178, s[8:11], s6 offen offset:3072 nt
  s_waitcnt vmcnt(7)
  s_add_u32 s6, s74, 0x600000
  buffer_load_dwordx4 a[192:195], v178, s[8:11], s6 offen offset:0 nt
  s_waitcnt vmcnt(7)
  buffer_load_dwordx4 a[196:199], v178, s[8:11], s6 offen offset:1024 nt
  s_waitcnt vmcnt(7)
  buffer_load_dwordx4 a[200:203], v178, s[8:11], s6 offen offset:2048 nt
  s_waitcnt vmcnt(7)
  buffer_load_dwordx4 a[204:207], v178, s[8:11], s6 offen offset:3072 nt
  s_waitcnt vmcnt(7)
  s_add_u32 s6, s74, 0x680000
  buffer_load_dwordx4 a[208:211], v178, s[8:11], s6 offen offset:0 nt
  s_waitcnt vmcnt(7)
  buffer_load_dwordx4 a[212:215], v178, s[8:11], s6 offen offset:1024 nt
  s_waitcnt vmcnt(7)
  v_cmp_gt_u32 vcc, 4, v190
  s_cbranch_vccz L_ok_7
  s_mov_b32 s7, 0
L_retry_6:
  s_mov_b64 exec, vcc
  buffer_load_dword v190, v181, s[44:47], 0 offen sc1
  s_mov_b64 exec, -1
  s_waitcnt vmcnt(0)
  v_cmp_gt_u32 vcc, 4, v190
  s_add_u32 s7, s7, 1
  s_cmp_ge_u32 s7, 65536
  s_cbranch_scc1 L_ok_7
  s_cbranch_vccnz L_retry_6
L_ok_7:
  s_lshl_b32 s62, s3, 9
  v_lshrrev_b32 v6, 5, v1
  v_and_b32 v7, 31, v1
  v_lshlrev_b32 v6, 11, v6
  v_lshl_add_u32 v6, v7, 4, v6
  v_add_u32 v184, s62, v6
  s_lshl_b32 s63, s4, 13
  s_add_u32 s63, s63, 0x10000
  s_add_u32 s62, s63, 4096
  buffer_load_dwordx4 v[138:141], v184, s[16:19], s63 offen sc1
  buffer_load_dwordx4 v[142:145], v184, s[16:19], s62 offen sc1
  s_waitcnt vmcnt(8)
  buffer_load_dwordx4 a[216:219], v178, s[8:11], s6 offen offset:2048 nt
  s_waitcnt vmcnt(8)
  buffer_load_dwordx4 a[220:223], v178, s[8:11], s6 offen offset:3072 nt
  s_waitcnt vmcnt(8)
  s_add_u32 s6, s74, 0x700000
  buffer_load_dwordx4 a[224:227], v178, s[8:11], s6 offen offset:0 nt
  s_waitcnt vmcnt(8)
  buffer_load_dwordx4 a[228:231], v178, s[8:11], s6 offen offset:1024 nt
  s_waitcnt vmcnt(8)
  buffer_load_dwordx4 a[232:235], v178, s[8:11], s6 offen offset:2048 nt
  s_waitcnt vmcnt(8)
  buffer_load_dwordx4 a[236:239], v178, s[8:11], s6 offen offset:3072 nt
  s_waitcnt vmcnt(8)
  s_add_u32 s6, s74, 0x780000
  buffer_load_dwordx4 a[240:243], v178, s[8:11], s6 offen offset:0 nt
  s_waitcnt vmcnt(7)
  s_lshl_b32 s63, s4, 13
  s_add_u32 s63, s63, 0x10000
  s_add_u32 s62, s63, 4096
  v_max_u32 v6, v138, v139
  v_max_u32 v7, v142, v143
  v_max3_u32 v6, v6, v140, v141
  v_max3_u32 v7, v7, v144, v145
  v_max_u32 v6, v6, v7
  v_cmp_eq_u32 vcc, -1, v6
  s_cbranch_vccz L_ok_9
  s_mov_b32 s7, 0
L_retry_8:
  s_mov_b64 exec, vcc
  buffer_load_dwordx4 v[138:141], v184, s[16:19], s63 offen sc1
  buffer_load_dwordx4 v[142:145], v184, s[16:19], s62 offen sc1
  s_mov_b64 exec, -1
  s_waitcnt vmcnt(0)
  v_max_u32 v6, v138, v139
  v_max_u32 v7, v142, v143
  v_max3_u32 v6, v6, v140, v141
  v_max3_u32 v7, v7, v144, v145
  v_max_u32 v6, v6, v7
  v_cmp_eq_u32 vcc, -1, v6
  s_add_u32 s7, s7, 1
  s_cmp_ge_u32 s7, 65536
  s_cbranch_scc1 L_ok_9
  s_cbranch_vccnz L_retry_8
L_ok_9:
  v_pk_add_f32 v[138:139], v[138:139], v[142:143]
  v_pk_add_f32 v[140:141], v[140:141], v[144:145]
  v_mov_b32 v142, v138
  v_mov_b32 v143, v139
  v_mov_b32 v144, v140
  v_mov_b32 v145, v141
  v_permlane32_swap_b32 v138, v142
  v_permlane32_swap_b32 v139, v143
  v_permlane32_swap_b32 v140, v144
  v_permlane32_swap_b32 v141, v145
  v_add_f32 v138, v138, v142
  v_add_f32 v139, v139, v143
  v_add_f32 v140, v140, v144
  v_add_f32 v141, v141, v145
  v_cvt_pk_bf16_f32 v10, v138, v139
  v_cvt_pk_bf16_f32 v11, v140, v141
  ds_write_b64 v179, v[10:11] offset:51200
  s_waitcnt vmcnt(6)
  buffer_load_dwordx4 a[244:247], v178, s[8:11], s6 offen offset:1024 nt
  s_waitcnt lgkmcnt(0)
  s_barrier
  ds_read_b128 v[22:25], v178 offset:51200
  s_waitcnt lgkmcnt(0)
  s_waitcnt vmcnt(6)
  buffer_load_dwordx4 a[248:251], v178, s[8:11], s6 offen offset:2048 nt
  v_mfma_f32_16x16x32_bf16 v[42:45], a[0:3], v[22:25], 0
  v_mfma_f32_16x16x32_bf16 v[46:49], a[4:7], v[22:25], 0
  v_mfma_f32_16x16x32_bf16 v[50:53], a[8:11], v[22:25], 0
  v_mfma_f32_16x16x32_bf16 v[54:57], a[12:15], v[22:25], 0
  s_nop 7
  v_cndmask_b32_e64 v10, v54, v51, s[54:55]
  v_cndmask_b32_e64 v11, v48, v45, s[54:55]
  v_cndmask_b32_e64 v9, v10, v11, s[56:57]
  v_cndmask_b32_e64 v10, v50, v55, s[54:55]
  v_cndmask_b32_e64 v11, v44, v49, s[54:55]
  v_cndmask_b32_e64 v8, v10, v11, s[56:57]
  v_cndmask_b32_e64 v10, v46, v43, s[54:55]
  v_cndmask_b32_e64 v11, v56, v53, s[54:55]
  v_cndmask_b32_e64 v7, v10, v11, s[56:57]
  v_cndmask_b32_e64 v10, v42, v47, s[54:55]
  v_cndmask_b32_e64 v11, v52, v57, s[54:55]
  v_cndmask_b32_e64 v6, v10, v11, s[56:57]
  v_add_f32_dpp v8, v9, v8 quad_perm:[1,0,3,2] row_mask:0xf bank_mask:0xf
  s_nop 0
  v_add_f32_dpp v6, v7, v6 quad_perm:[1,0,3,2] row_mask:0xf bank_mask:0xf
  s_nop 1
  v_add_f32_dpp v6, v8, v6 quad_perm:[2,3,0,1] row_mask:0xf bank_mask:0xf
  v_cvt_pk_bf16_f32 v6, v6, v6
  v_lshlrev_b32 v6, 16, v6
  v_mul_f32 v6, s68, v6
  v_cvt_pk_bf16_f32 v26, v6, v6
  v_lshlrev_b32 v26, 16, v26
  s_waitcnt vmcnt(6)
  buffer_load_dwordx4 a[252:255], v178, s[8:11], s6 offen offset:3072 nt
  v_mfma_f32_16x16x32_bf16 v[42:45], a[16:19], v[22:25], 0
  v_mfma_f32_16x16x32_bf16 v[46:49], a[20:23], v[22:25], 0
  v_mfma_f32_16x16x32_bf16 v[50:53], a[24:27], v[22:25], 0
  v_mfma_f32_16x16x32_bf16 v[54:57], a[28:31], v[22:25], 0
  s_nop 7
  v_cndmask_b32_e64 v10, v54, v51, s[54:55]
  v_cndmask_b32_e64 v11, v48, v45, s[54:55]
  v_cndmask_b32_e64 v9, v10, v11, s[56:57]
  v_cndmask_b32_e64 v10, v50, v55, s[54:55]
  v_cndmask_b32_e64 v11, v44, v49, s[54:55]
  v_cndmask_b32_e64 v8, v10, v11, s[56:57]
  v_cndmask_b32_e64 v10, v46, v43, s[54:55]
  v_cndmask_b32_e64 v11, v56, v53, s[54:55]
  v_cndmask_b32_e64 v7, v10, v11, s[56:57]
  v_cndmask_b32_e64 v10, v42, v47, s[54:55]
  v_cndmask_b32_e64 v11, v52, v57, s[54:55]
  v_cndmask_b32_e64 v6, v10, v11, s[56:57]
  v_add_f32_dpp v8, v9, v8 quad_perm:[1,0,3,2] row_mask:0xf bank_mask:0xf
  s_nop 0
  v_add_f32_dpp v6, v7, v6 quad_perm:[1,0,3,2] row_mask:0xf bank_mask:0xf
  s_nop 1
  v_add_f32_dpp v6, v8, v6 quad_perm:[2,3,0,1] row_mask:0xf bank_mask:0xf
  v_cvt_pk_bf16_f32 v6, v6, v6
  v_lshlrev_b32 v6, 16, v6
  v_mul_f32 v6, s68, v6
  v_cvt_pk_bf16_f32 v27, v6, v6
  v_lshlrev_b32 v27, 16, v27
  s_waitcnt vmcnt(6)
  buffer_load_dwordx4 a[0:3], v3, s[12:15], s74 offen offset:0 nt
  v_mfma_f32_16x16x32_bf16 v[42:45], a[32:35], v[22:25], 0
  v_mfma_f32_16x16x32_bf16 v[46:49], a[36:39], v[22:25], 0
  v_mfma_f32_16x16x32_bf16 v[50:53], a[40:43], v[22:25], 0
  v_mfma_f32_16x16x32_bf16 v[54:57], a[44:47], v[22:25], 0
  s_nop 7
  v_cndmask_b32_e64 v10, v54, v51, s[54:55]
  v_cndmask_b32_e64 v11, v48, v45, s[54:55]
  v_cndmask_b32_e64 v9, v10, v11, s[56:57]
  v_cndmask_b32_e64 v10, v50, v55, s[54:55]
  v_cndmask_b32_e64 v11, v44, v49, s[54:55]
  v_cndmask_b32_e64 v8, v10, v11, s[56:57]
  v_cndmask_b32_e64 v10, v46, v43, s[54:55]
  v_cndmask_b32_e64 v11, v56, v53, s[54:55]
  v_cndmask_b32_e64 v7, v10, v11, s[56:57]
  v_cndmask_b32_e64 v10, v42, v47, s[54:55]
  v_cndmask_b32_e64 v11, v52, v57, s[54:55]
  v_cndmask_b32_e64 v6, v10, v11, s[56:57]
  v_add_f32_dpp v8, v9, v8 quad_perm:[1,0,3,2] row_mask:0xf bank_mask:0xf
  s_nop 0
  v_add_f32_dpp v6, v7, v6 quad_perm:[1,0,3,2] row_mask:0xf bank_mask:0xf
  s_nop 1
  v_add_f32_dpp v6, v8, v6 quad_perm:[2,3,0,1] row_mask:0xf bank_mask:0xf
  v_cvt_pk_bf16_f32 v6, v6, v6
  v_lshlrev_b32 v6, 16, v6
  v_mul_f32 v6, s68, v6
  v_cvt_pk_bf16_f32 v28, v6, v6
  v_lshlrev_b32 v28, 16, v28
  s_waitcnt vmcnt(6)
  buffer_load_dwordx4 a[4:7], v3, s[12:15], s74 offen offset:1024 nt
  v_mfma_f32_16x16x32_bf16 v[42:45], a[48:51], v[22:25], 0
  v_mfma_f32_16x16x32_bf16 v[46:49], a[52:55], v[22:25], 0
  v_mfma_f32_16x16x32_bf16 v[50:53], a[56:59], v[22:25], 0
  v_mfma_f32_16x16x32_bf16 v[54:57], a[60:63], v[22:25], 0
  s_nop 7
  v_cndmask_b32_e64 v10, v54, v51, s[54:55]
  v_cndmask_b32_e64 v11, v48, v45, s[54:55]
  v_cndmask_b32_e64 v9, v10, v11, s[56:57]
  v_cndmask_b32_e64 v10, v50, v55, s[54:55]
  v_cndmask_b32_e64 v11, v44, v49, s[54:55]
  v_cndmask_b32_e64 v8, v10, v11, s[56:57]
  v_cndmask_b32_e64 v10, v46, v43, s[54:55]
  v_cndmask_b32_e64 v11, v56, v53, s[54:55]
  v_cndmask_b32_e64 v7, v10, v11, s[56:57]
  v_cndmask_b32_e64 v10, v42, v47, s[54:55]
  v_cndmask_b32_e64 v11, v52, v57, s[54:55]
  v_cndmask_b32_e64 v6, v10, v11, s[56:57]
  v_add_f32_dpp v8, v9, v8 quad_perm:[1,0,3,2] row_mask:0xf bank_mask:0xf
  s_nop 0
  v_add_f32_dpp v6, v7, v6 quad_perm:[1,0,3,2] row_mask:0xf bank_mask:0xf
  s_nop 1
  v_add_f32_dpp v6, v8, v6 quad_perm:[2,3,0,1] row_mask:0xf bank_mask:0xf
  v_cvt_pk_bf16_f32 v6, v6, v6
  v_lshlrev_b32 v6, 16, v6
  v_mul_f32 v6, s68, v6
  v_cvt_pk_bf16_f32 v29, v6, v6
  v_lshlrev_b32 v29, 16, v29
  s_waitcnt vmcnt(6)
  buffer_load_dwordx4 a[8:11], v3, s[12:15], s74 offen offset:2048 nt
  v_mfma_f32_16x16x32_bf16 v[42:45], a[64:67], v[22:25], 0
  v_mfma_f32_16x16x32_bf16 v[46:49], a[68:71], v[22:25], 0
  v_mfma_f32_16x16x32_bf16 v[50:53], a[72:75], v[22:25], 0
  v_mfma_f32_16x16x32_bf16 v[54:57], a[76:79], v[22:25], 0
  s_nop 7
  v_cndmask_b32_e64 v10, v54, v51, s[54:55]
  v_cndmask_b32_e64 v11, v48, v45, s[54:55]
  v_cndmask_b32_e64 v9, v10, v11, s[56:57]
  v_cndmask_b32_e64 v10, v50, v55, s[54:55]
  v_cndmask_b32_e64 v11, v44, v49, s[54:55]
  v_cndmask_b32_e64 v8, v10, v11, s[56:57]
  v_cndmask_b32_e64 v10, v46, v43, s[54:55]
  v_cndmask_b32_e64 v11, v56, v53, s[54:55]
  v_cndmask_b32_e64 v7, v10, v11, s[56:57]
  v_cndmask_b32_e64 v10, v42, v47, s[54:55]
  v_cndmask_b32_e64 v11, v52, v57, s[54:55]
  v_cndmask_b32_e64 v6, v10, v11, s[56:57]
  v_add_f32_dpp v8, v9, v8 quad_perm:[1,0,3,2] row_mask:0xf bank_mask:0xf
  s_nop 0
  v_add_f32_dpp v6, v7, v6 quad_perm:[1,0,3,2] row_mask:0xf bank_mask:0xf
  s_nop 1
  v_add_f32_dpp v6, v8, v6 quad_perm:[2,3,0,1] row_mask:0xf bank_mask:0xf
  v_cvt_pk_bf16_f32 v6, v6, v6
  v_lshlrev_b32 v6, 16, v6
  v_mul_f32 v6, s68, v6
  v_cvt_pk_bf16_f32 v30, v6, v6
  v_lshlrev_b32 v30, 16, v30
  s_waitcnt vmcnt(6)
  buffer_load_dwordx4 a[12:15], v3, s[12:15], s74 offen offset:3072 nt
  v_mfma_f32_16x16x32_bf16 v[42:45], a[80:83], v[22:25], 0
  v_mfma_f32_16x16x32_bf16 v[46:49], a[84:87], v[22:25], 0
  v_mfma_f32_16x16x32_bf16 v[50:53], a[88:91], v[22:25], 0
  v_mfma_f32_16x16x32_bf16 v[54:57], a[92:95], v[22:25], 0
  s_nop 7
  v_cndmask_b32_e64 v10, v54, v51, s[54:55]
  v_cndmask_b32_e64 v11, v48, v45, s[54:55]
  v_cndmask_b32_e64 v9, v10, v11, s[56:57]
  v_cndmask_b32_e64 v10, v50, v55, s[54:55]
  v_cndmask_b32_e64 v11, v44, v49, s[54:55]
  v_cndmask_b32_e64 v8, v10, v11, s[56:57]
  v_cndmask_b32_e64 v10, v46, v43, s[54:55]
  v_cndmask_b32_e64 v11, v56, v53, s[54:55]
  v_cndmask_b32_e64 v7, v10, v11, s[56:57]
  v_cndmask_b32_e64 v10, v42, v47, s[54:55]
  v_cndmask_b32_e64 v11, v52, v57, s[54:55]
  v_cndmask_b32_e64 v6, v10, v11, s[56:57]
  v_add_f32_dpp v8, v9, v8 quad_perm:[1,0,3,2] row_mask:0xf bank_mask:0xf
  s_nop 0
  v_add_f32_dpp v6, v7, v6 quad_perm:[1,0,3,2] row_mask:0xf bank_mask:0xf
  s_nop 1
  v_add_f32_dpp v6, v8, v6 quad_perm:[2,3,0,1] row_mask:0xf bank_mask:0xf
  v_cvt_pk_bf16_f32 v6, v6, v6
  v_lshlrev_b32 v6, 16, v6
  v_mul_f32 v6, s68, v6
  v_cvt_pk_bf16_f32 v31, v6, v6
  v_lshlrev_b32 v31, 16, v31
  s_waitcnt vmcnt(6)
  s_add_u32 s6, s74, 0x80000
  buffer_load_dwordx4 a[16:19], v3, s[12:15], s6 offen offset:0 nt
  v_mfma_f32_16x16x32_bf16 v[42:45], a[96:99], v[22:25], 0
  v_mfma_f32_16x16x32_bf16 v[46:49], a[100:103], v[22:25], 0
  v_mfma_f32_16x16x32_bf16 v[50:53], a[104:107], v[22:25], 0
  v_mfma_f32_16x16x32_bf16 v[54:57], a[108:111], v[22:25], 0
  s_nop 7
  v_cndmask_b32_e64 v10, v54, v51, s[54:55]
  v_cndmask_b32_e64 v11, v48, v45, s[54:55]
  v_cndmask_b32_e64 v9, v10, v11, s[56:57]
  v_cndmask_b32_e64 v10, v50, v55, s[54:55]
  v_cndmask_b32_e64 v11, v44, v49, s[54:55]
  v_cndmask_b32_e64 v8, v10, v11, s[56:57]
  v_cndmask_b32_e64 v10, v46, v43, s[54:55]
  v_cndmask_b32_e64 v11, v56, v53, s[54:55]
  v_cndmask_b32_e64 v7, v10, v11, s[56:57]
  v_cndmask_b32_e64 v10, v42, v47, s[54:55]
  v_cndmask_b32_e64 v11, v52, v57, s[54:55]
  v_cndmask_b32_e64 v6, v10, v11, s[56:57]
  v_add_f32_dpp v8, v9, v8 quad_perm:[1,0,3,2] row_mask:0xf bank_mask:0xf
  s_nop 0
  v_add_f32_dpp v6, v7, v6 quad_perm:[1,0,3,2] row_mask:0xf bank_mask:0xf
  s_nop 1
  v_add_f32_dpp v6, v8, v6 quad_perm:[2,3,0,1] row_mask:0xf bank_mask:0xf
  v_cvt_pk_bf16_f32 v6, v6, v6
  v_lshlrev_b32 v6, 16, v6
  v_mul_f32 v6, s68, v6
  v_cvt_pk_bf16_f32 v32, v6, v6
  v_lshlrev_b32 v32, 16, v32
  s_waitcnt vmcnt(6)
  buffer_load_dwordx4 a[20:23], v3, s[12:15], s6 offen offset:1024 nt
  v_mfma_f32_16x16x32_bf16 v[42:45], a[112:115], v[22:25], 0
  v_mfma_f32_16x16x32_bf16 v[46:49], a[116:119], v[22:25], 0
  v_mfma_f32_16x16x32_bf16 v[50:53], a[120:123], v[22:25], 0
  v_mfma_f32_16x16x32_bf16 v[54:57], a[124:127], v[22:25], 0
  s_nop 7
  v_cndmask_b32_e64 v10, v54, v51, s[54:55]
  v_cndmask_b32_e64 v11, v48, v45, s[54:55]
  v_cndmask_b32_e64 v9, v10, v11, s[56:57]
  v_cndmask_b32_e64 v10, v50, v55, s[54:55]
  v_cndmask_b32_e64 v11, v44, v49, s[54:55]
  v_cndmask_b32_e64 v8, v10, v11, s[56:57]
  v_cndmask_b32_e64 v10, v46, v43, s[54:55]
  v_cndmask_b32_e64 v11, v56, v53, s[54:55]
  v_cndmask_b32_e64 v7, v10, v11, s[56:57]
  v_cndmask_b32_e64 v10, v42, v47, s[54:55]
  v_cndmask_b32_e64 v11, v52, v57, s[54:55]
  v_cndmask_b32_e64 v6, v10, v11, s[56:57]
  v_add_f32_dpp v8, v9, v8 quad_perm:[1,0,3,2] row_mask:0xf bank_mask:0xf
  s_nop 0
  v_add_f32_dpp v6, v7, v6 quad_perm:[1,0,3,2] row_mask:0xf bank_mask:0xf
  s_nop 1
  v_add_f32_dpp v6, v8, v6 quad_perm:[2,3,0,1] row_mask:0xf bank_mask:0xf
  v_cvt_pk_bf16_f32 v6, v6, v6
  v_lshlrev_b32 v6, 16, v6
  v_mul_f32 v6, s68, v6
  v_cvt_pk_bf16_f32 v33, v6, v6
  v_lshlrev_b32 v33, 16, v33
  s_waitcnt vmcnt(6)
  buffer_load_dwordx4 a[24:27], v3, s[12:15], s6 offen offset:2048 nt
  v_mfma_f32_16x16x32_bf16 v[42:45], a[128:131], v[22:25], 0
  v_mfma_f32_16x16x32_bf16 v[46:49], a[132:135], v[22:25], 0
  v_mfma_f32_16x16x32_bf16 v[50:53], a[136:139], v[22:25], 0
  v_mfma_f32_16x16x32_bf16 v[54:57], a[140:143], v[22:25], 0
  s_nop 7
  v_cndmask_b32_e64 v10, v54, v51, s[54:55]
  v_cndmask_b32_e64 v11, v48, v45, s[54:55]
  v_cndmask_b32_e64 v9, v10, v11, s[56:57]
  v_cndmask_b32_e64 v10, v50, v55, s[54:55]
  v_cndmask_b32_e64 v11, v44, v49, s[54:55]
  v_cndmask_b32_e64 v8, v10, v11, s[56:57]
  v_cndmask_b32_e64 v10, v46, v43, s[54:55]
  v_cndmask_b32_e64 v11, v56, v53, s[54:55]
  v_cndmask_b32_e64 v7, v10, v11, s[56:57]
  v_cndmask_b32_e64 v10, v42, v47, s[54:55]
  v_cndmask_b32_e64 v11, v52, v57, s[54:55]
  v_cndmask_b32_e64 v6, v10, v11, s[56:57]
  v_add_f32_dpp v8, v9, v8 quad_perm:[1,0,3,2] row_mask:0xf bank_mask:0xf
  s_nop 0
  v_add_f32_dpp v6, v7, v6 quad_perm:[1,0,3,2] row_mask:0xf bank_mask:0xf
  s_nop 1
  v_add_f32_dpp v6, v8, v6 quad_perm:[2,3,0,1] row_mask:0xf bank_mask:0xf
  v_cvt_pk_bf16_f32 v6, v6, v6
  v_lshlrev_b32 v6, 16, v6
  v_mul_f32 v6, s68, v6
  v_cvt_pk_bf16_f32 v34, v6, v6
  v_lshlrev_b32 v34, 16, v34
  s_waitcnt vmcnt(6)
  buffer_load_dwordx4 a[28:31], v3, s[12:15], s6 offen offset:3072 nt
  v_mfma_f32_16x16x32_bf16 v[42:45], a[144:147], v[22:25], 0
  v_mfma_f32_16x16x32_bf16 v[46:49], a[148:151], v[22:25], 0
  v_mfma_f32_16x16x32_bf16 v[50:53], a[152:155], v[22:25], 0
  v_mfma_f32_16x16x32_bf16 v[54:57], a[156:159], v[22:25], 0
  s_nop 7
  v_cndmask_b32_e64 v10, v54, v51, s[54:55]
  v_cndmask_b32_e64 v11, v48, v45, s[54:55]
  v_cndmask_b32_e64 v9, v10, v11, s[56:57]
  v_cndmask_b32_e64 v10, v50, v55, s[54:55]
  v_cndmask_b32_e64 v11, v44, v49, s[54:55]
  v_cndmask_b32_e64 v8, v10, v11, s[56:57]
  v_cndmask_b32_e64 v10, v46, v43, s[54:55]
  v_cndmask_b32_e64 v11, v56, v53, s[54:55]
  v_cndmask_b32_e64 v7, v10, v11, s[56:57]
  v_cndmask_b32_e64 v10, v42, v47, s[54:55]
  v_cndmask_b32_e64 v11, v52, v57, s[54:55]
  v_cndmask_b32_e64 v6, v10, v11, s[56:57]
  v_add_f32_dpp v8, v9, v8 quad_perm:[1,0,3,2] row_mask:0xf bank_mask:0xf
  s_nop 0
  v_add_f32_dpp v6, v7, v6 quad_perm:[1,0,3,2] row_mask:0xf bank_mask:0xf
  s_nop 1
  v_add_f32_dpp v6, v8, v6 quad_perm:[2,3,0,1] row_mask:0xf bank_mask:0xf
  v_cvt_pk_bf16_f32 v6, v6, v6
  v_lshlrev_b32 v6, 16, v6
  v_mul_f32 v6, s68, v6
  v_cvt_pk_bf16_f32 v35, v6, v6
  v_lshlrev_b32 v35, 16, v35
  s_waitcnt vmcnt(6)
  s_add_u32 s6, s74, 0x100000
  buffer_load_dwordx4 a[32:35], v3, s[12:15], s6 offen offset:0 nt
  v_mfma_f32_16x16x32_bf16 v[42:45], a[160:163], v[22:25], 0
  v_mfma_f32_16x16x32_bf16 v[46:49], a[164:167], v[22:25], 0
  v_mfma_f32_16x16x32_bf16 v[50:53], a[168:171], v[22:25], 0
  v_mfma_f32_16x16x32_bf16 v[54:57], a[172:175], v[22:25], 0
  s_nop 7
  v_cndmask_b32_e64 v10, v54, v51, s[54:55]
  v_cndmask_b32_e64 v11, v48, v45, s[54:55]
  v_cndmask_b32_e64 v9, v10, v11, s[56:57]
  v_cndmask_b32_e64 v10, v50, v55, s[54:55]
  v_cndmask_b32_e64 v11, v44, v49, s[54:55]
  v_cndmask_b32_e64 v8, v10, v11, s[56:57]
  v_cndmask_b32_e64 v10, v46, v43, s[54:55]
  v_cndmask_b32_e64 v11, v56, v53, s[54:55]
  v_cndmask_b32_e64 v7, v10, v11, s[56:57]
  v_cndmask_b32_e64 v10, v42, v47, s[54:55]
  v_cndmask_b32_e64 v11, v52, v57, s[54:55]
  v_cndmask_b32_e64 v6, v10, v11, s[56:57]
  v_add_f32_dpp v8, v9, v8 quad_perm:[1,0,3,2] row_mask:0xf bank_mask:0xf
  s_nop 0
  v_add_f32_dpp v6, v7, v6 quad_perm:[1,0,3,2] row_mask:0xf bank_mask:0xf
  s_nop 1
  v_add_f32_dpp v6, v8, v6 quad_perm:[2,3,0,1] row_mask:0xf bank_mask:0xf
  v_cvt_pk_bf16_f32 v6, v6, v6
  v_lshlrev_b32 v6, 16, v6
  v_mul_f32 v6, s68, v6
  v_cvt_pk_bf16_f32 v36, v6, v6
  v_lshlrev_b32 v36, 16, v36
  s_waitcnt vmcnt(6)
  buffer_load_dwordx4 a[36:39], v3, s[12:15], s6 offen offset:1024 nt
  v_mfma_f32_16x16x32_bf16 v[42:45], a[176:179], v[22:25], 0
  v_mfma_f32_16x16x32_bf16 v[46:49], a[180:183], v[22:25], 0
  v_mfma_f32_16x16x32_bf16 v[50:53], a[184:187], v[22:25], 0
  v_mfma_f32_16x16x32_bf16 v[54:57], a[188:191], v[22:25], 0
  s_nop 7
  v_cndmask_b32_e64 v10, v54, v51, s[54:55]
  v_cndmask_b32_e64 v11, v48, v45, s[54:55]
  v_cndmask_b32_e64 v9, v10, v11, s[56:57]
  v_cndmask_b32_e64 v10, v50, v55, s[54:55]
  v_cndmask_b32_e64 v11, v44, v49, s[54:55]
  v_cndmask_b32_e64 v8, v10, v11, s[56:57]
  v_cndmask_b32_e64 v10, v46, v43, s[54:55]
  v_cndmask_b32_e64 v11, v56, v53, s[54:55]
  v_cndmask_b32_e64 v7, v10, v11, s[56:57]
  v_cndmask_b32_e64 v10, v42, v47, s[54:55]
  v_cndmask_b32_e64 v11, v52, v57, s[54:55]
  v_cndmask_b32_e64 v6, v10, v11, s[56:57]
  v_add_f32_dpp v8, v9, v8 quad_perm:[1,0,3,2] row_mask:0xf bank_mask:0xf
  s_nop 0
  v_add_f32_dpp v6, v7, v6 quad_perm:[1,0,3,2] row_mask:0xf bank_mask:0xf
  s_nop 1
  v_add_f32_dpp v6, v8, v6 quad_perm:[2,3,0,1] row_mask:0xf bank_mask:0xf
  v_cvt_pk_bf16_f32 v6, v6, v6
  v_lshlrev_b32 v6, 16, v6
  v_mul_f32 v6, s68, v6
  v_cvt_pk_bf16_f32 v37, v6, v6
  v_lshlrev_b32 v37, 16, v37
  s_waitcnt vmcnt(6)
  buffer_load_dwordx4 a[40:43], v3, s[12:15], s6 offen offset:2048 nt
  v_mfma_f32_16x16x32_bf16 v[42:45], a[192:195], v[22:25], 0
  v_mfma_f32_16x16x32_bf16 v[46:49], a[196:199], v[22:25], 0
  v_mfma_f32_16x16x32_bf16 v[50:53], a[200:203], v[22:25], 0
  v_mfma_f32_16x16x32_bf16 v[54:57], a[204:207], v[22:25], 0
  s_nop 7
  v_cndmask_b32_e64 v10, v54, v51, s[54:55]
  v_cndmask_b32_e64 v11, v48, v45, s[54:55]
  v_cndmask_b32_e64 v9, v10, v11, s[56:57]
  v_cndmask_b32_e64 v10, v50, v55, s[54:55]
  v_cndmask_b32_e64 v11, v44, v49, s[54:55]
  v_cndmask_b32_e64 v8, v10, v11, s[56:57]
  v_cndmask_b32_e64 v10, v46, v43, s[54:55]
  v_cndmask_b32_e64 v11, v56, v53, s[54:55]
  v_cndmask_b32_e64 v7, v10, v11, s[56:57]
  v_cndmask_b32_e64 v10, v42, v47, s[54:55]
  v_cndmask_b32_e64 v11, v52, v57, s[54:55]
  v_cndmask_b32_e64 v6, v10, v11, s[56:57]
  v_add_f32_dpp v8, v9, v8 quad_perm:[1,0,3,2] row_mask:0xf bank_mask:0xf
  s_nop 0
  v_add_f32_dpp v6, v7, v6 quad_perm:[1,0,3,2] row_mask:0xf bank_mask:0xf
  s_nop 1
  v_add_f32_dpp v6, v8, v6 quad_perm:[2,3,0,1] row_mask:0xf bank_mask:0xf
  v_cvt_pk_bf16_f32 v6, v6, v6
  v_lshlrev_b32 v6, 16, v6
  v_mul_f32 v6, s68, v6
  v_cvt_pk_bf16_f32 v38, v6, v6
  v_lshlrev_b32 v38, 16, v38
  s_waitcnt vmcnt(6)
  buffer_load_dwordx4 a[44:47], v3, s[12:15], s6 offen offset:3072 nt
  v_mfma_f32_16x16x32_bf16 v[42:45], a[208:211], v[22:25], 0
  v_mfma_f32_16x16x32_bf16 v[46:49], a[212:215], v[22:25], 0
  v_mfma_f32_16x16x32_bf16 v[50:53], a[216:219], v[22:25], 0
  v_mfma_f32_16x16x32_bf16 v[54:57], a[220:223], v[22:25], 0
  s_nop 7
  v_cndmask_b32_e64 v10, v54, v51, s[54:55]
  v_cndmask_b32_e64 v11, v48, v45, s[54:55]
  v_cndmask_b32_e64 v9, v10, v11, s[56:57]
  v_cndmask_b32_e64 v10, v50, v55, s[54:55]
  v_cndmask_b32_e64 v11, v44, v49, s[54:55]
  v_cndmask_b32_e64 v8, v10, v11, s[56:57]
  v_cndmask_b32_e64 v10, v46, v43, s[54:55]
  v_cndmask_b32_e64 v11, v56, v53, s[54:55]
  v_cndmask_b32_e64 v7, v10, v11, s[56:57]
  v_cndmask_b32_e64 v10, v42, v47, s[54:55]
  v_cndmask_b32_e64 v11, v52, v57, s[54:55]
  v_cndmask_b32_e64 v6, v10, v11, s[56:57]
  v_add_f32_dpp v8, v9, v8 quad_perm:[1,0,3,2] row_mask:0xf bank_mask:0xf
  s_nop 0
  v_add_f32_dpp v6, v7, v6 quad_perm:[1,0,3,2] row_mask:0xf bank_mask:0xf
  s_nop 1
  v_add_f32_dpp v6, v8, v6 quad_perm:[2,3,0,1] row_mask:0xf bank_mask:0xf
  v_cvt_pk_bf16_f32 v6, v6, v6
  v_lshlrev_b32 v6, 16, v6
  v_mul_f32 v6, s68, v6
  v_cvt_pk_bf16_f32 v39, v6, v6
  v_lshlrev_b32 v39, 16, v39
  s_waitcnt vmcnt(6)
  s_add_u32 s6, s74, 0x180000
  buffer_load_dwordx4 a[48:51], v3, s[12:15], s6 offen offset:0 nt
  v_mfma_f32_16x16x32_bf16 v[42:45], a[224:227], v[22:25], 0
  v_mfma_f32_16x16x32_bf16 v[46:49], a[228:231], v[22:25], 0
  v_mfma_f32_16x16x32_bf16 v[50:53], a[232:235], v[22:25], 0
  v_mfma_f32_16x16x32_bf16 v[54:57], a[236:239], v[22:25], 0
  s_nop 7
  v_cndmask_b32_e64 v10, v54, v51, s[54:55]
  v_cndmask_b32_e64 v11, v48, v45, s[54:55]
  v_cndmask_b32_e64 v9, v10, v11, s[56:57]
  v_cndmask_b32_e64 v10, v50, v55, s[54:55]
  v_cndmask_b32_e64 v11, v44, v49, s[54:55]
  v_cndmask_b32_e64 v8, v10, v11, s[56:57]
  v_cndmask_b32_e64 v10, v46, v43, s[54:55]
  v_cndmask_b32_e64 v11, v56, v53, s[54:55]
  v_cndmask_b32_e64 v7, v10, v11, s[56:57]
  v_cndmask_b32_e64 v10, v42, v47, s[54:55]
  v_cndmask_b32_e64 v11, v52, v57, s[54:55]
  v_cndmask_b32_e64 v6, v10, v11, s[56:57]
  v_add_f32_dpp v8, v9, v8 quad_perm:[1,0,3,2] row_mask:0xf bank_mask:0xf
  s_nop 0
  v_add_f32_dpp v6, v7, v6 quad_perm:[1,0,3,2] row_mask:0xf bank_mask:0xf
  s_nop 1
  v_add_f32_dpp v6, v8, v6 quad_perm:[2,3,0,1] row_mask:0xf bank_mask:0xf
  v_cvt_pk_bf16_f32 v6, v6, v6
  v_lshlrev_b32 v6, 16, v6
  v_mul_f32 v6, s68, v6
  v_cvt_pk_bf16_f32 v40, v6, v6
  v_lshlrev_b32 v40, 16, v40
  s_waitcnt vmcnt(6)
  buffer_load_dwordx4 a[52:55], v3, s[12:15], s6 offen offset:1024 nt
  v_mfma_f32_16x16x32_bf16 v[42:45], a[240:243], v[22:25], 0
  v_mfma_f32_16x16x32_bf16 v[46:49], a[244:247], v[22:25], 0
  v_mfma_f32_16x16x32_bf16 v[50:53], a[248:251], v[22:25], 0
  v_mfma_f32_16x16x32_bf16 v[54:57], a[252:255], v[22:25], 0
  s_nop 7
  v_cndmask_b32_e64 v10, v54, v51, s[54:55]
  v_cndmask_b32_e64 v11, v48, v45, s[54:55]
  v_cndmask_b32_e64 v9, v10, v11, s[56:57]
  v_cndmask_b32_e64 v10, v50, v55, s[54:55]
  v_cndmask_b32_e64 v11, v44, v49, s[54:55]
  v_cndmask_b32_e64 v8, v10, v11, s[56:57]
  v_cndmask_b32_e64 v10, v46, v43, s[54:55]
  v_cndmask_b32_e64 v11, v56, v53, s[54:55]
  v_cndmask_b32_e64 v7, v10, v11, s[56:57]
  v_cndmask_b32_e64 v10, v42, v47, s[54:55]
  v_cndmask_b32_e64 v11, v52, v57, s[54:55]
  v_cndmask_b32_e64 v6, v10, v11, s[56:57]
  v_add_f32_dpp v8, v9, v8 quad_perm:[1,0,3,2] row_mask:0xf bank_mask:0xf
  s_nop 0
  v_add_f32_dpp v6, v7, v6 quad_perm:[1,0,3,2] row_mask:0xf bank_mask:0xf
  s_nop 1
  v_add_f32_dpp v6, v8, v6 quad_perm:[2,3,0,1] row_mask:0xf bank_mask:0xf
  v_cvt_pk_bf16_f32 v6, v6, v6
  v_lshlrev_b32 v6, 16, v6
  v_mul_f32 v6, s68, v6
  v_cvt_pk_bf16_f32 v41, v6, v6
  v_lshlrev_b32 v41, 16, v41
  s_waitcnt vmcnt(6)
  buffer_load_dwordx4 a[56:59], v3, s[12:15], s6 offen offset:2048 nt
  v_max3_f32 v188, v26, v27, v28
  v_max3_f32 v188, v188, v29, v30
  v_max3_f32 v188, v188, v31, v32
  v_max3_f32 v188, v188, v33, v34
  v_max3_f32 v188, v188, v35, v36
  v_max3_f32 v188, v188, v37, v38
  v_max3_f32 v188, v188, v39, v40
  v_max_f32 v188, v188, v41
  s_nop 1
  v_max_f32_dpp v188, v188, v188 quad_perm:[1,0,3,2] row_mask:0xf bank_mask:0xf
  s_nop 1
  v_max_f32_dpp v188, v188, v188 quad_perm:[2,3,0,1] row_mask:0xf bank_mask:0xf
  v_mov_b32 v6, v188
  s_nop 1
  v_permlane16_swap_b32 v188, v6
  v_max_f32 v188, v188, v6
  v_mov_b32 v6, v188
  s_nop 1
  v_permlane32_swap_b32 v188, v6
  v_max_f32 v188, v188, v6
  s_waitcnt vmcnt(6)
  buffer_load_dwordx4 a[60:63], v3, s[12:15], s6 offen offset:3072 nt
  v_sub_f32 v42, v26, v188
  v_mul_f32 v42, s67, v42
  v_exp_f32 v42, v42
  v_sub_f32 v43, v27, v188
  v_mul_f32 v43, s67, v43
  v_exp_f32 v43, v43
  v_sub_f32 v44, v28, v188
  v_mul_f32 v44, s67, v44
  v_exp_f32 v44, v44
  v_sub_f32 v45, v29, v188
  v_mul_f32 v45, s67, v45
  v_exp_f32 v45, v45
  v_sub_f32 v46, v30, v188
  v_mul_f32 v46, s67, v46
  v_exp_f32 v46, v46
  v_sub_f32 v47, v31, v188
  v_mul_f32 v47, s67, v47
  v_exp_f32 v47, v47
  v_sub_f32 v48, v32, v188
  v_mul_f32 v48, s67, v48
  v_exp_f32 v48, v48
  v_sub_f32 v49, v33, v188
  v_mul_f32 v49, s67, v49
  v_exp_f32 v49, v49
  v_sub_f32 v50, v34, v188
  v_mul_f32 v50, s67, v50
  v_exp_f32 v50, v50
  v_sub_f32 v51, v35, v188
  v_mul_f32 v51, s67, v51
  v_exp_f32 v51, v51
  s_waitcnt vmcnt(6)
  s_add_u32 s6, s74, 0x200000
  buffer_load_dwordx4 a[64:67], v3, s[12:15], s6 offen offset:0 nt
  v_sub_f32 v52, v36, v188
  v_mul_f32 v52, s67, v52
  v_exp_f32 v52, v52
  v_sub_f32 v53, v37, v188
  v_mul_f32 v53, s67, v53
  v_exp_f32 v53, v53
  v_sub_f32 v54, v38, v188
  v_mul_f32 v54, s67, v54
  v_exp_f32 v54, v54
  v_sub_f32 v55, v39, v188
  v_mul_f32 v55, s67, v55
  v_exp_f32 v55, v55
  v_sub_f32 v56, v40, v188
  v_mul_f32 v56, s67, v56
  v_exp_f32 v56, v56
  v_sub_f32 v57, v41, v188
  v_mul_f32 v57, s67, v57
  v_exp_f32 v57, v57
  s_nop 0
  v_add_f32 v42, v42, v50
  v_add_f32 v43, v43, v51
  v_add_f32 v44, v44, v52
  v_add_f32 v45, v45, v53
  v_add_f32 v46, v46, v54
  v_add_f32 v47, v47, v55
  v_add_f32 v48, v48, v56
  v_add_f32 v49, v49, v57
  v_add_f32 v42, v42, v46
  v_add_f32 v43, v43, v47
  v_add_f32 v44, v44, v48
  v_add_f32 v45, v45, v49
  v_add_f32 v42, v42, v44
  v_add_f32 v43, v43, v45
  v_add_f32 v42, v42, v43
  s_waitcnt vmcnt(6)
  buffer_load_dwordx4 a[68:71], v3, s[12:15], s6 offen offset:1024 nt
  s_nop 1
  v_add_f32_dpp v42, v42, v42 quad_perm:[1,0,3,2] row_mask:0xf bank_mask:0xf
  s_nop 1
  v_add_f32_dpp v42, v42, v42 quad_perm:[2,3,0,1] row_mask:0xf bank_mask:0xf
  v_mov_b32 v6, v42
  s_nop 1
  v_permlane16_swap_b32 v42, v6
  v_add_f32 v42, v42, v6
  v_mov_b32 v6, v42
  s_nop 1
  v_permlane32_swap_b32 v42, v6
  v_add_f32 v42, v42, v6
  v_mov_b32 v10, v188
  v_mov_b32 v11, v42
  v_bfe_u32 v6, v1, 2, 2
  s_lshl_b32 s62, s3, 3
  s_add_u32 s62, s62, 54912
  v_lshl_add_u32 v7, v6, 5, s62
  s_mov_b64 exec, 0x1111
  ds_write_b64 v7, v[10:11]
  s_mov_b64 exec, -1
  s_waitcnt vmcnt(6)
  buffer_load_dwordx4 a[72:75], v3, s[12:15], s6 offen offset:2048 nt
  s_waitcnt lgkmcnt(0)
  s_barrier
  s_cmp_lg_u32 s3, 0
  s_cbranch_scc1 L_nost_10
  s_mov_b64 exec, 0x1111
  v_lshlrev_b32 v7, 5, v6
  ds_read_b128 v[42:45], v7 offset:54912
  ds_read_b128 v[46:49], v7 offset:54928
  s_lshl_b32 s62, s4, 5
  s_add_u32 s62, s62, s5
  s_lshl_b32 s62, s62, 7
  s_add_u32 s62, s62, 0x60000
  v_lshlrev_b32 v7, 3, v6
  s_waitcnt lgkmcnt(0)
  v_max3_f32 v10, v42, v44, v46
  v_max_f32 v10, v10, v48
  v_sub_f32 v42, v42, v10
  v_mul_f32 v42, s67, v42
  v_exp_f32 v42, v42
  v_sub_f32 v44, v44, v10
  v_mul_f32 v44, s67, v44
  v_exp_f32 v44, v44
  v_sub_f32 v46, v46, v10
  v_mul_f32 v46, s67, v46
  v_exp_f32 v46, v46
  v_sub_f32 v48, v48, v10
  v_mul_f32 v48, s67, v48
  v_exp_f32 v48, v48
  s_nop 0
  v_mul_f32 v11, v42, v43
  v_fmac_f32 v11, v44, v45
  v_fmac_f32 v11, v46, v47
  v_fmac_f32 v11, v48, v49
  buffer_store_dwordx2 v[10:11], v7, s[16:19], s62 offen sc1
  s_mov_b64 exec, -1
L_nost_10:
  s_waitcnt vmcnt(6)
  buffer_load_dwordx4 a[76:79], v3, s[12:15], s6 offen offset:3072 nt
  s_waitcnt vmcnt(6)
  s_add_u32 s6, s74, 0x280000
  buffer_load_dwordx4 a[80:83], v3, s[12:15], s6 offen offset:0 nt
  s_waitcnt vmcnt(6)
  buffer_load_dwordx4 a[84:87], v3, s[12:15], s6 offen offset:1024 nt
  s_waitcnt vmcnt(6)
  buffer_load_dwordx4 a[88:91], v3, s[12:15], s6 offen offset:2048 nt
  s_waitcnt vmcnt(6)
  buffer_load_dwordx4 a[92:95], v3, s[12:15], s6 offen offset:3072 nt
  s_waitcnt vmcnt(6)
  s_add_u32 s6, s74, 0x300000
  buffer_load_dwordx4 a[96:99], v3, s[12:15], s6 offen offset:0 nt
  s_waitcnt vmcnt(6)
  buffer_load_dwordx4 a[100:103], v3, s[12:15], s6 offen offset:1024 nt
  s_waitcnt vmcnt(6)
  buffer_load_dwordx4 a[104:107], v3, s[12:15], s6 offen offset:2048 nt
  s_waitcnt vmcnt(6)
  buffer_load_dwordx4 a[108:111], v3, s[12:15], s6 offen offset:3072 nt
  s_waitcnt vmcnt(6)
  s_add_u32 s6, s74, 0x380000
  buffer_load_dwordx4 a[112:115], v3, s[12:15], s6 offen offset:0 nt
  s_waitcnt vmcnt(6)
  buffer_load_dwordx4 a[116:119], v3, s[12:15], s6 offen offset:1024 nt
  s_waitcnt vmcnt(6)
  buffer_load_dwordx4 a[120:123], v3, s[12:15], s6 offen offset:2048 nt
  s_waitcnt vmcnt(6)
  buffer_load_dwordx4 a[124:127], v3, s[12:15], s6 offen offset:3072 nt
  s_waitcnt vmcnt(6)
  s_add_u32 s6, s74, 0x400000
  buffer_load_dwordx4 a[128:131], v3, s[12:15], s6 offen offset:0 nt
  s_waitcnt vmcnt(6)
  buffer_load_dwordx4 a[132:135], v3, s[12:15], s6 offen offset:1024 nt
  s_waitcnt vmcnt(6)
  buffer_load_dwordx4 a[136:139], v3, s[12:15], s6 offen offset:2048 nt
  s_waitcnt vmcnt(6)
  buffer_load_dwordx4 a[140:143], v3, s[12:15], s6 offen offset:3072 nt
  s_waitcnt vmcnt(6)
  s_add_u32 s6, s74, 0x480000
  buffer_load_dwordx4 a[144:147], v3, s[12:15], s6 offen offset:0 nt
  s_waitcnt vmcnt(6)
  buffer_load_dwordx4 a[148:151], v3, s[12:15], s6 offen offset:1024 nt
  v_lshrrev_b32 v6, 4, v1
  v_and_b32 v7, 3, v1
  v_lshl_add_u32 v6, v6, 2, v7
  v_bfe_u32 v7, v1, 2, 2
  v_lshlrev_b32 v7, 3, v7
  v_lshl_add_u32 v182, v6, 7, v7
  s_lshl_b32 s63, s4, 12
  s_add_u32 s63, s63, 0x60000
  buffer_load_dwordx2 v[194:195], v182, s[16:19], s63 offen sc1
  buffer_load_dwordx2 v[196:197], v182, s[16:19], s63 offen offset:2048 sc1
  s_waitcnt vmcnt(8)
  buffer_load_dwordx4 a[152:155], v3, s[12:15], s6 offen offset:2048 nt
  s_waitcnt vmcnt(8)
  buffer_load_dwordx4 a[156:159], v3, s[12:15], s6 offen offset:3072 nt
  s_waitcnt vmcnt(8)
  s_add_u32 s6, s74, 0x500000
  buffer_load_dwordx4 a[160:163], v3, s[12:15], s6 offen offset:0 nt
  s_waitcnt vmcnt(8)
  buffer_load_dwordx4 a[164:167], v3, s[12:15], s6 offen offset:1024 nt
  s_waitcnt vmcnt(8)
  buffer_load_dwordx4 a[168:171], v3, s[12:15], s6 offen offset:2048 nt
  s_waitcnt vmcnt(8)
  buffer_load_dwordx4 a[172:175], v3, s[12:15], s6 offen offset:3072 nt
  s_waitcnt vmcnt(8)
  s_add_u32 s6, s74, 0x580000
  buffer_load_dwordx4 a[176:179], v3, s[12:15], s6 offen offset:0 nt
  s_waitcnt vmcnt(7)
  s_lshl_b32 s63, s4, 12
  s_add_u32 s63, s63, 0x60000
  v_max3_u32 v6, v194, v195, v196
  v_max_u32 v6, v6, v197
  v_cmp_eq_u32 vcc, -1, v6
  s_cbranch_vccz L_ok_12
  s_mov_b32 s7, 0
L_retry_11:
  s_mov_b64 exec, vcc
  buffer_load_dwordx2 v[194:195], v182, s[16:19], s63 offen sc1
  buffer_load_dwordx2 v[196:197], v182, s[16:19], s63 offen offset:2048 sc1
  s_mov_b64 exec, -1
  s_waitcnt vmcnt(0)
  v_max3_u32 v6, v194, v195, v196
  v_max_u32 v6, v6, v197
  v_cmp_eq_u32 vcc, -1, v6
  s_add_u32 s7, s7, 1
  s_cmp_ge_u32 s7, 65536
  s_cbranch_scc1 L_ok_12
  s_cbranch_vccnz L_retry_11
L_ok_12:
  v_max_f32 v188, v194, v196
  s_nop 1
  v_max_f32_dpp v188, v188, v188 quad_perm:[1,0,3,2] row_mask:0xf bank_mask:0xf
  s_nop 1
  v_max_f32_dpp v188, v188, v188 quad_perm:[2,3,0,1] row_mask:0xf bank_mask:0xf
  v_mov_b32 v6, v188
  s_nop 1
  v_permlane16_swap_b32 v188, v6
  v_max_f32 v188, v188, v6
  v_mov_b32 v6, v188
  s_nop 1
  v_permlane32_swap_b32 v188, v6
  v_max_f32 v188, v188, v6
  s_waitcnt vmcnt(6)
  buffer_load_dwordx4 a[180:183], v3, s[12:15], s6 offen offset:1024 nt
  v_sub_f32 v194, v194, v188
  v_mul_f32 v194, s67, v194
  v_exp_f32 v194, v194
  v_sub_f32 v196, v196, v188
  v_mul_f32 v196, s67, v196
  v_exp_f32 v196, v196
  s_nop 0
  v_mul_f32 v189, v194, v195
  v_fmac_f32 v189, v196, v197
  s_nop 1
  v_add_f32_dpp v189, v189, v189 quad_perm:[1,0,3,2] row_mask:0xf bank_mask:0xf
  s_nop 1
  v_add_f32_dpp v189, v189, v189 quad_perm:[2,3,0,1] row_mask:0xf bank_mask:0xf
  v_mov_b32 v6, v189
  s_nop 1
  v_permlane16_swap_b32 v189, v6
  v_add_f32 v189, v189, v6
  v_mov_b32 v6, v189
  s_nop 1
  v_permlane32_swap_b32 v189, v6
  v_add_f32 v189, v189, v6
  v_rcp_f32 v189, v189
  v_sub_f32 v26, v26, v188
  v_mul_f32 v26, s67, v26
  v_exp_f32 v26, v26
  v_sub_f32 v27, v27, v188
  v_mul_f32 v27, s67, v27
  v_exp_f32 v27, v27
  v_sub_f32 v28, v28, v188
  v_mul_f32 v28, s67, v28
  v_exp_f32 v28, v28
  v_sub_f32 v29, v29, v188
  v_mul_f32 v29, s67, v29
  v_exp_f32 v29, v29
  v_sub_f32 v30, v30, v188
  v_mul_f32 v30, s67, v30
  v_exp_f32 v30, v30
  v_sub_f32 v31, v31, v188
  v_mul_f32 v31, s67, v31
  v_exp_f32 v31, v31
  v_sub_f32 v32, v32, v188
  v_mul_f32 v32, s67, v32
  v_exp_f32 v32, v32
  v_sub_f32 v33, v33, v188
  v_mul_f32 v33, s67, v33
  v_exp_f32 v33, v33
  v_sub_f32 v34, v34, v188
  v_mul_f32 v34, s67, v34
  v_exp_f32 v34, v34
  v_sub_f32 v35, v35, v188
  v_mul_f32 v35, s67, v35
  v_exp_f32 v35, v35
  s_waitcnt vmcnt(6)
  buffer_load_dwordx4 a[184:187], v3, s[12:15], s6 offen offset:2048 nt
  v_sub_f32 v36, v36, v188
  v_mul_f32 v36, s67, v36
  v_exp_f32 v36, v36
  v_sub_f32 v37, v37, v188
  v_mul_f32 v37, s67, v37
  v_exp_f32 v37, v37
  v_sub_f32 v38, v38, v188
  v_mul_f32 v38, s67, v38
  v_exp_f32 v38, v38
  v_sub_f32 v39, v39, v188
  v_mul_f32 v39, s67, v39
  v_exp_f32 v39, v39
  v_sub_f32 v40, v40, v188
  v_mul_f32 v40, s67, v40
  v_exp_f32 v40, v40
  v_sub_f32 v41, v41, v188
  v_mul_f32 v41, s67, v41
  v_exp_f32 v41, v41
  s_waitcnt vmcnt(6)
  buffer_load_dwordx4 a[188:191], v3, s[12:15], s6 offen offset:3072 nt
  v_mul_f32 v26, v26, v189
  v_mul_f32 v27, v27, v189
  v_mul_f32 v28, v28, v189
  v_mul_f32 v29, v29, v189
  v_mul_f32 v30, v30, v189
  v_mul_f32 v31, v31, v189
  v_mul_f32 v32, v32, v189
  v_mul_f32 v33, v33, v189
  v_mul_f32 v34, v34, v189
  v_mul_f32 v35, v35, v189
  v_mul_f32 v36, v36, v189
  v_mul_f32 v37, v37, v189
  v_mul_f32 v38, v38, v189
  v_mul_f32 v39, v39, v189
  v_mul_f32 v40, v40, v189
  v_mul_f32 v41, v41, v189
  v_cvt_pk_bf16_f32 v26, v26, v26
  v_cvt_pk_bf16_f32 v27, v27, v27
  v_cvt_pk_bf16_f32 v28, v28, v28
  v_cvt_pk_bf16_f32 v29, v29, v29
  v_cvt_pk_bf16_f32 v30, v30, v30
  v_cvt_pk_bf16_f32 v31, v31, v31
  v_cvt_pk_bf16_f32 v32, v32, v32
  v_cvt_pk_bf16_f32 v33, v33, v33
  v_cvt_pk_bf16_f32 v34, v34, v34
  v_cvt_pk_bf16_f32 v35, v35, v35
  v_cvt_pk_bf16_f32 v36, v36, v36
  v_cvt_pk_bf16_f32 v37, v37, v37
  v_cvt_pk_bf16_f32 v38, v38, v38
  v_cvt_pk_bf16_f32 v39, v39, v39
  v_cvt_pk_bf16_f32 v40, v40, v40
  v_cvt_pk_bf16_f32 v41, v41, v41
  s_nop 1
  s_waitcnt vmcnt(6)
  s_add_u32 s6, s74, 0x600000
  buffer_load_dwordx4 a[192:195], v3, s[12:15], s6 offen offset:0 nt
  s_waitcnt vmcnt(6)
  buffer_load_dwordx4 a[196:199], v3, s[12:15], s6 offen offset:1024 nt
  v_and_b32_dpp v66, v26, v4 quad_perm:[0,0,0,0] row_mask:0xf bank_mask:0xf
  v_and_b32_dpp v67, v26, v5 quad_perm:[0,0,0,0] row_mask:0xf bank_mask:0xf
  v_and_b32_dpp v68, v26, v4 quad_perm:[1,1,1,1] row_mask:0xf bank_mask:0xf
  v_and_b32_dpp v69, v26, v5 quad_perm:[1,1,1,1] row_mask:0xf bank_mask:0xf
  v_mfma_f32_16x16x16_bf16 v[58:61], v[66:67], a[0:1], v[58:61]
  v_mfma_f32_16x16x16_bf16 v[62:65], v[66:67], a[2:3], v[62:65]
  v_and_b32_dpp v70, v26, v4 quad_perm:[2,2,2,2] row_mask:0xf bank_mask:0xf
  v_and_b32_dpp v71, v26, v5 quad_perm:[2,2,2,2] row_mask:0xf bank_mask:0xf
  v_mfma_f32_16x16x16_bf16 v[58:61], v[68:69], a[4:5], v[58:61]
  v_mfma_f32_16x16x16_bf16 v[62:65], v[68:69], a[6:7], v[62:65]
  v_and_b32_dpp v72, v26, v4 quad_perm:[3,3,3,3] row_mask:0xf bank_mask:0xf
  v_and_b32_dpp v73, v26, v5 quad_perm:[3,3,3,3] row_mask:0xf bank_mask:0xf
  v_mfma_f32_16x16x16_bf16 v[58:61], v[70:71], a[8:9], v[58:61]
  v_mfma_f32_16x16x16_bf16 v[62:65], v[70:71], a[10:11], v[62:65]
  v_and_b32_dpp v66, v27, v4 quad_perm:[0,0,0,0] row_mask:0xf bank_mask:0xf
  v_and_b32_dpp v67, v27, v5 quad_perm:[0,0,0,0] row_mask:0xf bank_mask:0xf
  v_mfma_f32_16x16x16_bf16 v[58:61], v[72:73], a[12:13], v[58:61]
  v_mfma_f32_16x16x16_bf16 v[62:65], v[72:73], a[14:15], v[62:65]
  v_and_b32_dpp v68, v27, v4 quad_perm:[1,1,1,1] row_mask:0xf bank_mask:0xf
  v_and_b32_dpp v69, v27, v5 quad_perm:[1,1,1,1] row_mask:0xf bank_mask:0xf
  v_mfma_f32_16x16x16_bf16 v[58:61], v[66:67], a[16:17], v[58:61]
  v_mfma_f32_16x16x16_bf16 v[62:65], v[66:67], a[18:19], v[62:65]
  v_and_b32_dpp v70, v27, v4 quad_perm:[2,2,2,2] row_mask:0xf bank_mask:0xf
  v_and_b32_dpp v71, v27, v5 quad_perm:[2,2,2,2] row_mask:0xf bank_mask:0xf
  v_mfma_f32_16x16x16_bf16 v[58:61], v[68:69], a[20:21], v[58:61]
  v_mfma_f32_16x16x16_bf16 v[62:65], v[68:69], a[22:23], v[62:65]
  s_waitcnt vmcnt(6)
  buffer_load_dwordx4 a[200:203], v3, s[12:15], s6 offen offset:2048 nt
  v_and_b32_dpp v72, v27, v4 quad_perm:[3,3,3,3] row_mask:0xf bank_mask:0xf
  v_and_b32_dpp v73, v27, v5 quad_perm:[3,3,3,3] row_mask:0xf bank_mask:0xf
  v_mfma_f32_16x16x16_bf16 v[58:61], v[70:71], a[24:25], v[58:61]
  v_mfma_f32_16x16x16_bf16 v[62:65], v[70:71], a[26:27], v[62:65]
  v_and_b32_dpp v66, v28, v4 quad_perm:[0,0,0,0] row_mask:0xf bank_mask:0xf
  v_and_b32_dpp v67, v28, v5 quad_perm:[0,0,0,0] row_mask:0xf bank_mask:0xf
  v_mfma_f32_16x16x16_bf16 v[58:61], v[72:73], a[28:29], v[58:61]
  v_mfma_f32_16x16x16_bf16 v[62:65], v[72:73], a[30:31], v[62:65]
  v_and_b32_dpp v68, v28, v4 quad_perm:[1,1,1,1] row_mask:0xf bank_mask:0xf
  v_and_b32_dpp v69, v28, v5 quad_perm:[1,1,1,1] row_mask:0xf bank_mask:0xf
  v_mfma_f32_16x16x16_bf16 v[58:61], v[66:67], a[32:33], v[58:61]
  v_mfma_f32_16x16x16_bf16 v[62:65], v[66:67], a[34:35], v[62:65]
  v_and_b32_dpp v70, v28, v4 quad_perm:[2,2,2,2] row_mask:0xf bank_mask:0xf
  v_and_b32_dpp v71, v28, v5 quad_perm:[2,2,2,2] row_mask:0xf bank_mask:0xf
  v_mfma_f32_16x16x16_bf16 v[58:61], v[68:69], a[36:37], v[58:61]
  v_mfma_f32_16x16x16_bf16 v[62:65], v[68:69], a[38:39], v[62:65]
  v_and_b32_dpp v72, v28, v4 quad_perm:[3,3,3,3] row_mask:0xf bank_mask:0xf
  v_and_b32_dpp v73, v28, v5 quad_perm:[3,3,3,3] row_mask:0xf bank_mask:0xf
  v_mfma_f32_16x16x16_bf16 v[58:61], v[70:71], a[40:41], v[58:61]
  v_mfma_f32_16x16x16_bf16 v[62:65], v[70:71], a[42:43], v[62:65]
  v_and_b32_dpp v66, v29, v4 quad_perm:[0,0,0,0] row_mask:0xf bank_mask:0xf
  v_and_b32_dpp v67, v29, v5 quad_perm:[0,0,0,0] row_mask:0xf bank_mask:0xf
  v_mfma_f32_16x16x16_bf16 v[58:61], v[72:73], a[44:45], v[58:61]
  v_mfma_f32_16x16x16_bf16 v[62:65], v[72:73], a[46:47], v[62:65]
  s_waitcnt vmcnt(6)
  buffer_load_dwordx4 a[204:207], v3, s[12:15], s6 offen offset:3072 nt
  v_and_b32_dpp v68, v29, v4 quad_perm:[1,1,1,1] row_mask:0xf bank_mask:0xf
  v_and_b32_dpp v69, v29, v5 quad_perm:[1,1,1,1] row_mask:0xf bank_mask:0xf
  v_mfma_f32_16x16x16_bf16 v[58:61], v[66:67], a[48:49], v[58:61]
  v_mfma_f32_16x16x16_bf16 v[62:65], v[66:67], a[50:51], v[62:65]
  v_and_b32_dpp v70, v29, v4 quad_perm:[2,2,2,2] row_mask:0xf bank_mask:0xf
  v_and_b32_dpp v71, v29, v5 quad_perm:[2,2,2,2] row_mask:0xf bank_mask:0xf
  v_mfma_f32_16x16x16_bf16 v[58:61], v[68:69], a[52:53], v[58:61]
  v_mfma_f32_16x16x16_bf16 v[62:65], v[68:69], a[54:55], v[62:65]
  v_and_b32_dpp v72, v29, v4 quad_perm:[3,3,3,3] row_mask:0xf bank_mask:0xf
  v_and_b32_dpp v73, v29, v5 quad_perm:[3,3,3,3] row_mask:0xf bank_mask:0xf
  v_mfma_f32_16x16x16_bf16 v[58:61], v[70:71], a[56:57], v[58:61]
  v_mfma_f32_16x16x16_bf16 v[62:65], v[70:71], a[58:59], v[62:65]
  v_and_b32_dpp v66, v30, v4 quad_perm:[0,0,0,0] row_mask:0xf bank_mask:0xf
  v_and_b32_dpp v67, v30, v5 quad_perm:[0,0,0,0] row_mask:0xf bank_mask:0xf
  v_mfma_f32_16x16x16_bf16 v[58:61], v[72:73], a[60:61], v[58:61]
  v_mfma_f32_16x16x16_bf16 v[62:65], v[72:73], a[62:63], v[62:65]
  v_and_b32_dpp v68, v30, v4 quad_perm:[1,1,1,1] row_mask:0xf bank_mask:0xf
  v_and_b32_dpp v69, v30, v5 quad_perm:[1,1,1,1] row_mask:0xf bank_mask:0xf
  v_mfma_f32_16x16x16_bf16 v[58:61], v[66:67], a[64:65], v[58:61]
  v_mfma_f32_16x16x16_bf16 v[62:65], v[66:67], a[66:67], v[62:65]
  v_and_b32_dpp v70, v30, v4 quad_perm:[2,2,2,2] row_mask:0xf bank_mask:0xf
  v_and_b32_dpp v71, v30, v5 quad_perm:[2,2,2,2] row_mask:0xf bank_mask:0xf
  v_mfma_f32_16x16x16_bf16 v[58:61], v[68:69], a[68:69], v[58:61]
  v_mfma_f32_16x16x16_bf16 v[62:65], v[68:69], a[70:71], v[62:65]
  s_waitcnt vmcnt(6)
  s_add_u32 s6, s74, 0x680000
  buffer_load_dwordx4 a[208:211], v3, s[12:15], s6 offen offset:0 nt
  v_and_b32_dpp v72, v30, v4 quad_perm:[3,3,3,3] row_mask:0xf bank_mask:0xf
  v_and_b32_dpp v73, v30, v5 quad_perm:[3,3,3,3] row_mask:0xf bank_mask:0xf
  v_mfma_f32_16x16x16_bf16 v[58:61], v[70:71], a[72:73], v[58:61]
  v_mfma_f32_16x16x16_bf16 v[62:65], v[70:71], a[74:75], v[62:65]
  v_and_b32_dpp v66, v31, v4 quad_perm:[0,0,0,0] row_mask:0xf bank_mask:0xf
  v_and_b32_dpp v67, v31, v5 quad_perm:[0,0,0,0] row_mask:0xf bank_mask:0xf
  v_mfma_f32_16x16x16_bf16 v[58:61], v[72:73], a[76:77], v[58:61]
  v_mfma_f32_16x16x16_bf16 v[62:65], v[72:73], a[78:79], v[62:65]
  v_and_b32_dpp v68, v31, v4 quad_perm:[1,1,1,1] row_mask:0xf bank_mask:0xf
  v_and_b32_dpp v69, v31, v5 quad_perm:[1,1,1,1] row_mask:0xf bank_mask:0xf
  v_mfma_f32_16x16x16_bf16 v[58:61], v[66:67], a[80:81], v[58:61]
  v_mfma_f32_16x16x16_bf16 v[62:65], v[66:67], a[82:83], v[62:65]
  v_and_b32_dpp v70, v31, v4 quad_perm:[2,2,2,2] row_mask:0xf bank_mask:0xf
  v_and_b32_dpp v71, v31, v5 quad_perm:[2,2,2,2] row_mask:0xf bank_mask:0xf
  v_mfma_f32_16x16x16_bf16 v[58:61], v[68:69], a[84:85], v[58:61]
  v_mfma_f32_16x16x16_bf16 v[62:65], v[68:69], a[86:87], v[62:65]
  v_and_b32_dpp v72, v31, v4 quad_perm:[3,3,3,3] row_mask:0xf bank_mask:0xf
  v_and_b32_dpp v73, v31, v5 quad_perm:[3,3,3,3] row_mask:0xf bank_mask:0xf
  v_mfma_f32_16x16x16_bf16 v[58:61], v[70:71], a[88:89], v[58:61]
  v_mfma_f32_16x16x16_bf16 v[62:65], v[70:71], a[90:91], v[62:65]
  v_and_b32_dpp v66, v32, v4 quad_perm:[0,0,0,0] row_mask:0xf bank_mask:0xf
  v_and_b32_dpp v67, v32, v5 quad_perm:[0,0,0,0] row_mask:0xf bank_mask:0xf
  v_mfma_f32_16x16x16_bf16 v[58:61], v[72:73], a[92:93], v[58:61]
  v_mfma_f32_16x16x16_bf16 v[62:65], v[72:73], a[94:95], v[62:65]
  s_waitcnt vmcnt(6)
  buffer_load_dwordx4 a[212:215], v3, s[12:15], s6 offen offset:1024 nt
  v_and_b32_dpp v68, v32, v4 quad_perm:[1,1,1,1] row_mask:0xf bank_mask:0xf
  v_and_b32_dpp v69, v32, v5 quad_perm:[1,1,1,1] row_mask:0xf bank_mask:0xf
  v_mfma_f32_16x16x16_bf16 v[58:61], v[66:67], a[96:97], v[58:61]
  v_mfma_f32_16x16x16_bf16 v[62:65], v[66:67], a[98:99], v[62:65]
  v_and_b32_dpp v70, v32, v4 quad_perm:[2,2,2,2] row_mask:0xf bank_mask:0xf
  v_and_b32_dpp v71, v32, v5 quad_perm:[2,2,2,2] row_mask:0xf bank_mask:0xf
  v_mfma_f32_16x16x16_bf16 v[58:61], v[68:69], a[100:101], v[58:61]
  v_mfma_f32_16x16x16_bf16 v[62:65], v[68:69], a[102:103], v[62:65]
  v_and_b32_dpp v72, v32, v4 quad_perm:[3,3,3,3] row_mask:0xf bank_mask:0xf
  v_and_b32_dpp v73, v32, v5 quad_perm:[3,3,3,3] row_mask:0xf bank_mask:0xf
  v_mfma_f32_16x16x16_bf16 v[58:61], v[70:71], a[104:105], v[58:61]
  v_mfma_f32_16x16x16_bf16 v[62:65], v[70:71], a[106:107], v[62:65]
  v_and_b32_dpp v66, v33, v4 quad_perm:[0,0,0,0] row_mask:0xf bank_mask:0xf
  v_and_b32_dpp v67, v33, v5 quad_perm:[0,0,0,0] row_mask:0xf bank_mask:0xf
  v_mfma_f32_16x16x16_bf16 v[58:61], v[72:73], a[108:109], v[58:61]
  v_mfma_f32_16x16x16_bf16 v[62:65], v[72:73], a[110:111], v[62:65]
  v_and_b32_dpp v68, v33, v4 quad_perm:[1,1,1,1] row_mask:0xf bank_mask:0xf
  v_and_b32_dpp v69, v33, v5 quad_perm:[1,1,1,1] row_mask:0xf bank_mask:0xf
  v_mfma_f32_16x16x16_bf16 v[58:61], v[66:67], a[112:113], v[58:61]
  v_mfma_f32_16x16x16_bf16 v[62:65], v[66:67], a[114:115], v[62:65]
  v_and_b32_dpp v70, v33, v4 quad_perm:[2,2,2,2] row_mask:0xf bank_mask:0xf
  v_and_b32_dpp v71, v33, v5 quad_perm:[2,2,2,2] row_mask:0xf bank_mask:0xf
  v_mfma_f32_16x16x16_bf16 v[58:61], v[68:69], a[116:117], v[58:61]
  v_mfma_f32_16x16x16_bf16 v[62:65], v[68:69], a[118:119], v[62:65]
  s_waitcnt vmcnt(6)
  buffer_load_dwordx4 a[216:219], v3, s[12:15], s6 offen offset:2048 nt
  v_and_b32_dpp v72, v33, v4 quad_perm:[3,3,3,3] row_mask:0xf bank_mask:0xf
  v_and_b32_dpp v73, v33, v5 quad_perm:[3,3,3,3] row_mask:0xf bank_mask:0xf
  v_mfma_f32_16x16x16_bf16 v[58:61], v[70:71], a[120:121], v[58:61]
  v_mfma_f32_16x16x16_bf16 v[62:65], v[70:71], a[122:123], v[62:65]
  v_and_b32_dpp v66, v34, v4 quad_perm:[0,0,0,0] row_mask:0xf bank_mask:0xf
  v_and_b32_dpp v67, v34, v5 quad_perm:[0,0,0,0] row_mask:0xf bank_mask:0xf
  v_mfma_f32_16x16x16_bf16 v[58:61], v[72:73], a[124:125], v[58:61]
  v_mfma_f32_16x16x16_bf16 v[62:65], v[72:73], a[126:127], v[62:65]
  v_and_b32_dpp v68, v34, v4 quad_perm:[1,1,1,1] row_mask:0xf bank_mask:0xf
  v_and_b32_dpp v69, v34, v5 quad_perm:[1,1,1,1] row_mask:0xf bank_mask:0xf
  v_mfma_f32_16x16x16_bf16 v[58:61], v[66:67], a[128:129], v[58:61]
  v_mfma_f32_16x16x16_bf16 v[62:65], v[66:67], a[130:131], v[62:65]
  v_and_b32_dpp v70, v34, v4 quad_perm:[2,2,2,2] row_mask:0xf bank_mask:0xf
  v_and_b32_dpp v71, v34, v5 quad_perm:[2,2,2,2] row_mask:0xf bank_mask:0xf
  v_mfma_f32_16x16x16_bf16 v[58:61], v[68:69], a[132:133], v[58:61]
  v_mfma_f32_16x16x16_bf16 v[62:65], v[68:69], a[134:135], v[62:65]
  v_and_b32_dpp v72, v34, v4 quad_perm:[3,3,3,3] row_mask:0xf bank_mask:0xf
  v_and_b32_dpp v73, v34, v5 quad_perm:[3,3,3,3] row_mask:0xf bank_mask:0xf
  v_mfma_f32_16x16x16_bf16 v[58:61], v[70:71], a[136:137], v[58:61]
  v_mfma_f32_16x16x16_bf16 v[62:65], v[70:71], a[138:139], v[62:65]
  v_and_b32_dpp v66, v35, v4 quad_perm:[0,0,0,0] row_mask:0xf bank_mask:0xf
  v_and_b32_dpp v67, v35, v5 quad_perm:[0,0,0,0] row_mask:0xf bank_mask:0xf
  v_mfma_f32_16x16x16_bf16 v[58:61], v[72:73], a[140:141], v[58:61]
  v_mfma_f32_16x16x16_bf16 v[62:65], v[72:73], a[142:143], v[62:65]
  s_waitcnt vmcnt(6)
  buffer_load_dwordx4 a[220:223], v3, s[12:15], s6 offen offset:3072 nt
  v_and_b32_dpp v68, v35, v4 quad_perm:[1,1,1,1] row_mask:0xf bank_mask:0xf
  v_and_b32_dpp v69, v35, v5 quad_perm:[1,1,1,1] row_mask:0xf bank_mask:0xf
  v_mfma_f32_16x16x16_bf16 v[58:61], v[66:67], a[144:145], v[58:61]
  v_mfma_f32_16x16x16_bf16 v[62:65], v[66:67], a[146:147], v[62:65]
  v_and_b32_dpp v70, v35, v4 quad_perm:[2,2,2,2] row_mask:0xf bank_mask:0xf
  v_and_b32_dpp v71, v35, v5 quad_perm:[2,2,2,2] row_mask:0xf bank_mask:0xf
  v_mfma_f32_16x16x16_bf16 v[58:61], v[68:69], a[148:149], v[58:61]
  v_mfma_f32_16x16x16_bf16 v[62:65], v[68:69], a[150:151], v[62:65]
  v_and_b32_dpp v72, v35, v4 quad_perm:[3,3,3,3] row_mask:0xf bank_mask:0xf
  v_and_b32_dpp v73, v35, v5 quad_perm:[3,3,3,3] row_mask:0xf bank_mask:0xf
  v_mfma_f32_16x16x16_bf16 v[58:61], v[70:71], a[152:153], v[58:61]
  v_mfma_f32_16x16x16_bf16 v[62:65], v[70:71], a[154:155], v[62:65]
  v_and_b32_dpp v66, v36, v4 quad_perm:[0,0,0,0] row_mask:0xf bank_mask:0xf
  v_and_b32_dpp v67, v36, v5 quad_perm:[0,0,0,0] row_mask:0xf bank_mask:0xf
  v_mfma_f32_16x16x16_bf16 v[58:61], v[72:73], a[156:157], v[58:61]
  v_mfma_f32_16x16x16_bf16 v[62:65], v[72:73], a[158:159], v[62:65]
  v_and_b32_dpp v68, v36, v4 quad_perm:[1,1,1,1] row_mask:0xf bank_mask:0xf
  v_and_b32_dpp v69, v36, v5 quad_perm:[1,1,1,1] row_mask:0xf bank_mask:0xf
  v_mfma_f32_16x16x16_bf16 v[58:61], v[66:67], a[160:161], v[58:61]
  v_mfma_f32_16x16x16_bf16 v[62:65], v[66:67], a[162:163], v[62:65]
  v_and_b32_dpp v70, v36, v4 quad_perm:[2,2,2,2] row_mask:0xf bank_mask:0xf
  v_and_b32_dpp v71, v36, v5 quad_perm:[2,2,2,2] row_mask:0xf bank_mask:0xf
  v_mfma_f32_16x16x16_bf16 v[58:61], v[68:69], a[164:165], v[58:61]
  v_mfma_f32_16x16x16_bf16 v[62:65], v[68:69], a[166:167], v[62:65]
  s_waitcnt vmcnt(6)
  s_add_u32 s6, s74, 0x700000
  buffer_load_dwordx4 a[224:227], v3, s[12:15], s6 offen offset:0 nt
  v_and_b32_dpp v72, v36, v4 quad_perm:[3,3,3,3] row_mask:0xf bank_mask:0xf
  v_and_b32_dpp v73, v36, v5 quad_perm:[3,3,3,3] row_mask:0xf bank_mask:0xf
  v_mfma_f32_16x16x16_bf16 v[58:61], v[70:71], a[168:169], v[58:61]
  v_mfma_f32_16x16x16_bf16 v[62:65], v[70:71], a[170:171], v[62:65]
  v_and_b32_dpp v66, v37, v4 quad_perm:[0,0,0,0] row_mask:0xf bank_mask:0xf
  v_and_b32_dpp v67, v37, v5 quad_perm:[0,0,0,0] row_mask:0xf bank_mask:0xf
  v_mfma_f32_16x16x16_bf16 v[58:61], v[72:73], a[172:173], v[58:61]
  v_mfma_f32_16x16x16_bf16 v[62:65], v[72:73], a[174:175], v[62:65]
  v_and_b32_dpp v68, v37, v4 quad_perm:[1,1,1,1] row_mask:0xf bank_mask:0xf
  v_and_b32_dpp v69, v37, v5 quad_perm:[1,1,1,1] row_mask:0xf bank_mask:0xf
  v_mfma_f32_16x16x16_bf16 v[58:61], v[66:67], a[176:177], v[58:61]
  v_mfma_f32_16x16x16_bf16 v[62:65], v[66:67], a[178:179], v[62:65]
  v_and_b32_dpp v70, v37, v4 quad_perm:[2,2,2,2] row_mask:0xf bank_mask:0xf
  v_and_b32_dpp v71, v37, v5 quad_perm:[2,2,2,2] row_mask:0xf bank_mask:0xf
  v_mfma_f32_16x16x16_bf16 v[58:61], v[68:69], a[180:181], v[58:61]
  v_mfma_f32_16x16x16_bf16 v[62:65], v[68:69], a[182:183], v[62:65]
  v_and_b32_dpp v72, v37, v4 quad_perm:[3,3,3,3] row_mask:0xf bank_mask:0xf
  v_and_b32_dpp v73, v37, v5 quad_perm:[3,3,3,3] row_mask:0xf bank_mask:0xf
  v_mfma_f32_16x16x16_bf16 v[58:61], v[70:71], a[184:185], v[58:61]
  v_mfma_f32_16x16x16_bf16 v[62:65], v[70:71], a[186:187], v[62:65]
  v_and_b32_dpp v66, v38, v4 quad_perm:[0,0,0,0] row_mask:0xf bank_mask:0xf
  v_and_b32_dpp v67, v38, v5 quad_perm:[0,0,0,0] row_mask:0xf bank_mask:0xf
  v_mfma_f32_16x16x16_bf16 v[58:61], v[72:73], a[188:189], v[58:61]
  v_mfma_f32_16x16x16_bf16 v[62:65], v[72:73], a[190:191], v[62:65]
  s_waitcnt vmcnt(6)
  buffer_load_dwordx4 a[228:231], v3, s[12:15], s6 offen offset:1024 nt
  v_and_b32_dpp v68, v38, v4 quad_perm:[1,1,1,1] row_mask:0xf bank_mask:0xf
  v_and_b32_dpp v69, v38, v5 quad_perm:[1,1,1,1] row_mask:0xf bank_mask:0xf
  v_mfma_f32_16x16x16_bf16 v[58:61], v[66:67], a[192:193], v[58:61]
  v_mfma_f32_16x16x16_bf16 v[62:65], v[66:67], a[194:195], v[62:65]
  v_and_b32_dpp v70, v38, v4 quad_perm:[2,2,2,2] row_mask:0xf bank_mask:0xf
  v_and_b32_dpp v71, v38, v5 quad_perm:[2,2,2,2] row_mask:0xf bank_mask:0xf
  v_mfma_f32_16x16x16_bf16 v[58:61], v[68:69], a[196:197], v[58:61]
  v_mfma_f32_16x16x16_bf16 v[62:65], v[68:69], a[198:199], v[62:65]
  v_and_b32_dpp v72, v38, v4 quad_perm:[3,3,3,3] row_mask:0xf bank_mask:0xf
  v_and_b32_dpp v73, v38, v5 quad_perm:[3,3,3,3] row_mask:0xf bank_mask:0xf
  v_mfma_f32_16x16x16_bf16 v[58:61], v[70:71], a[200:201], v[58:61]
  v_mfma_f32_16x16x16_bf16 v[62:65], v[70:71], a[202:203], v[62:65]
  s_waitcnt vmcnt(6)
  buffer_load_dwordx4 a[232:235], v3, s[12:15], s6 offen offset:2048 nt
  v_and_b32_dpp v66, v39, v4 quad_perm:[0,0,0,0] row_mask:0xf bank_mask:0xf
  v_and_b32_dpp v67, v39, v5 quad_perm:[0,0,0,0] row_mask:0xf bank_mask:0xf
  v_mfma_f32_16x16x16_bf16 v[58:61], v[72:73], a[204:205], v[58:61]
  v_mfma_f32_16x16x16_bf16 v[62:65], v[72:73], a[206:207], v[62:65]
  s_waitcnt vmcnt(6)
  buffer_load_dwordx4 a[236:239], v3, s[12:15], s6 offen offset:3072 nt
  v_and_b32_dpp v68, v39, v4 quad_perm:[1,1,1,1] row_mask:0xf bank_mask:0xf
  v_and_b32_dpp v69, v39, v5 quad_perm:[1,1,1,1] row_mask:0xf bank_mask:0xf
  v_mfma_f32_16x16x16_bf16 v[58:61], v[66:67], a[208:209], v[58:61]
  v_mfma_f32_16x16x16_bf16 v[62:65], v[66:67], a[210:211], v[62:65]
  s_waitcnt vmcnt(6)
  s_add_u32 s6, s74, 0x780000
  buffer_load_dwordx4 a[240:243], v3, s[12:15], s6 offen offset:0 nt
  v_and_b32_dpp v70, v39, v4 quad_perm:[2,2,2,2] row_mask:0xf bank_mask:0xf
  v_and_b32_dpp v71, v39, v5 quad_perm:[2,2,2,2] row_mask:0xf bank_mask:0xf
  v_mfma_f32_16x16x16_bf16 v[58:61], v[68:69], a[212:213], v[58:61]
  v_mfma_f32_16x16x16_bf16 v[62:65], v[68:69], a[214:215], v[62:65]
  s_waitcnt vmcnt(6)
  buffer_load_dwordx4 a[244:247], v3, s[12:15], s6 offen offset:1024 nt
  v_and_b32_dpp v72, v39, v4 quad_perm:[3,3,3,3] row_mask:0xf bank_mask:0xf
  v_and_b32_dpp v73, v39, v5 quad_perm:[3,3,3,3] row_mask:0xf bank_mask:0xf
  v_mfma_f32_16x16x16_bf16 v[58:61], v[70:71], a[216:217], v[58:61]
  v_mfma_f32_16x16x16_bf16 v[62:65], v[70:71], a[218:219], v[62:65]
  s_waitcnt vmcnt(6)
  buffer_load_dwordx4 a[248:251], v3, s[12:15], s6 offen offset:2048 nt
  v_and_b32_dpp v66, v40, v4 quad_perm:[0,0,0,0] row_mask:0xf bank_mask:0xf
  v_and_b32_dpp v67, v40, v5 quad_perm:[0,0,0,0] row_mask:0xf bank_mask:0xf
  v_mfma_f32_16x16x16_bf16 v[58:61], v[72:73], a[220:221], v[58:61]
  v_mfma_f32_16x16x16_bf16 v[62:65], v[72:73], a[222:223], v[62:65]
  s_waitcnt vmcnt(6)
  buffer_load_dwordx4 a[252:255], v3, s[12:15], s6 offen offset:3072 nt
  v_and_b32_dpp v68, v40, v4 quad_perm:[1,1,1,1] row_mask:0xf bank_mask:0xf
  v_and_b32_dpp v69, v40, v5 quad_perm:[1,1,1,1] row_mask:0xf bank_mask:0xf
  v_mfma_f32_16x16x16_bf16 v[58:61], v[66:67], a[224:225], v[58:61]
  v_mfma_f32_16x16x16_bf16 v[62:65], v[66:67], a[226:227], v[62:65]
  s_cmp_eq_u32 s71, 2
  s_cbranch_scc1 L_roleD
  s_cmp_eq_u32 s71, 1
  s_cbranch_scc1 L_roleC
L_roleB:
  s_lshr_b32 s62, s66, 1
  s_lshl_b32 s62, s62, 16
  s_and_b32 s63, s66, 1
  s_lshl_b32 s63, s63, 10
  s_add_u32 s62, s62, s63
  s_lshl_b32 s63, s3, 8
  s_add_u32 s62, s62, s63
  v_lshrrev_b32 v8, 4, v1
  v_and_b32 v10, 15, v1
  v_lshlrev_b32 v6, 11, v8
  v_lshl_add_u32 v6, v10, 4, v6
  v_add_u32 v184, s62, v6
  s_lshl_b32 s62, s3, 13
  v_lshrrev_b32 v6, 5, v1
  v_lshlrev_b32 v6, 10, v6
  v_and_b32 v7, 31, v1
  v_lshl_add_u32 v6, v7, 3, v6
  v_add_u32 v9, s62, v6
  s_lshl_b32 s62, s3, 9
  v_lshl_add_u32 v180, v1, 3, s62
  s_add_u32 s62, s62, 32768
  v_and_b32 v6, 3, v1
  v_lshl_add_u32 v6, v6, 7, s62
  v_lshl_add_u32 v181, v8, 3, v6
  s_lshl_b32 s62, s3, 2
  v_lshl_add_u32 v182, v1, 4, s62
  s_lshl_b32 s62, s66, 11
  s_lshl_b32 s63, s65, 8
  s_add_u32 s62, s62, s63
  s_add_u32 s62, s62, 0x4000
  v_lshl_add_u32 v185, v1, 2, s62
  v_lshlrev_b32 v187, 4, v1
  s_lshl_b32 s62, s3, 13
  s_add_u32 m0, s62, 0
  s_mul_i32 s63, s69, 0
  buffer_load_dwordx4 v183, s[28:31], s63 offen nt lds
  s_lshl_b32 s62, s3, 13
  s_add_u32 m0, s62, 1024
  s_mul_i32 s63, s69, 1
  buffer_load_dwordx4 v183, s[28:31], s63 offen nt lds
  s_lshl_b32 s62, s3, 11
  v_lshl_add_u32 v16, v1, 5, s62
  s_lshl_b32 s62, s3, 9
  v_and_b32 v17, 31, v1
  v_lshl_add_u32 v17, v17, 4, s62
  v_and_b32_dpp v70, v40, v4 quad_perm:[2,2,2,2] row_mask:0xf bank_mask:0xf
  v_and_b32_dpp v71, v40, v5 quad_perm:[2,2,2,2] row_mask:0xf bank_mask:0xf
  s_waitcnt vmcnt(8)
  v_mfma_f32_16x16x16_bf16 v[58:61], v[68:69], a[228:229], v[58:61]
  v_mfma_f32_16x16x16_bf16 v[62:65], v[68:69], a[230:231], v[62:65]
  s_lshl_b32 s62, s3, 13
  s_add_u32 m0, s62, 2048
  s_mul_i32 s63, s69, 2
  buffer_load_dwordx4 v183, s[28:31], s63 offen nt lds
  v_and_b32_dpp v72, v40, v4 quad_perm:[3,3,3,3] row_mask:0xf bank_mask:0xf
  v_and_b32_dpp v73, v40, v5 quad_perm:[3,3,3,3] row_mask:0xf bank_mask:0xf
  s_waitcnt vmcnt(8)
  v_mfma_f32_16x16x16_bf16 v[58:61], v[70:71], a[232:233], v[58:61]
  v_mfma_f32_16x16x16_bf16 v[62:65], v[70:71], a[234:235], v[62:65]
  s_lshl_b32 s62, s3, 13
  s_add_u32 m0, s62, 3072
  s_mul_i32 s63, s69, 3
  buffer_load_dwordx4 v183, s[28:31], s63 offen nt lds
  v_and_b32_dpp v66, v41, v4 quad_perm:[0,0,0,0] row_mask:0xf bank_mask:0xf
  v_and_b32_dpp v67, v41, v5 quad_perm:[0,0,0,0] row_mask:0xf bank_mask:0xf
  s_waitcnt vmcnt(8)
  v_mfma_f32_16x16x16_bf16 v[58:61], v[72:73], a[236:237], v[58:61]
  v_mfma_f32_16x16x16_bf16 v[62:65], v[72:73], a[238:239], v[62:65]
  s_lshl_b32 s62, s3, 13
  s_add_u32 m0, s62, 4096
  s_mul_i32 s63, s69, 0
  s_add_u32 s63, s63, s70
  buffer_load_dwordx4 v183, s[32:35], s63 offen nt lds
  v_and_b32_dpp v68, v41, v4 quad_perm:[1,1,1,1] row_mask:0xf bank_mask:0xf
  v_and_b32_dpp v69, v41, v5 quad_perm:[1,1,1,1] row_mask:0xf bank_mask:0xf
  s_waitcnt vmcnt(8)
  v_mfma_f32_16x16x16_bf16 v[58:61], v[66:67], a[240:241], v[58:61]
  v_mfma_f32_16x16x16_bf16 v[62:65], v[66:67], a[242:243], v[62:65]
  s_lshl_b32 s62, s3, 13
  s_add_u32 m0, s62, 5120
  s_mul_i32 s63, s69, 1
  s_add_u32 s63, s63, s70
  buffer_load_dwordx4 v183, s[32:35], s63 offen nt lds
  v_and_b32_dpp v70, v41, v4 quad_perm:[2,2,2,2] row_mask:0xf bank_mask:0xf
  v_and_b32_dpp v71, v41, v5 quad_perm:[2,2,2,2] row_mask:0xf bank_mask:0xf
  s_waitcnt vmcnt(8)
  v_mfma_f32_16x16x16_bf16 v[58:61], v[68:69], a[244:245], v[58:61]
  v_mfma_f32_16x16x16_bf16 v[62:65], v[68:69], a[246:247], v[62:65]
  s_lshl_b32 s62, s3, 13
  s_add_u32 m0, s62, 6144
  s_mul_i32 s63, s69, 2
  s_add_u32 s63, s63, s70
  buffer_load_dwordx4 v183, s[32:35], s63 offen nt lds
  v_and_b32_dpp v72, v41, v4 quad_perm:[3,3,3,3] row_mask:0xf bank_mask:0xf
  v_and_b32_dpp v73, v41, v5 quad_perm:[3,3,3,3] row_mask:0xf bank_mask:0xf
  s_waitcnt vmcnt(8)
  v_mfma_f32_16x16x16_bf16 v[58:61], v[70:71], a[248:249], v[58:61]
  v_mfma_f32_16x16x16_bf16 v[62:65], v[70:71], a[250:251], v[62:65]
  s_lshl_b32 s62, s3, 13
  s_add_u32 m0, s62, 7168
  s_mul_i32 s63, s69, 3
  s_add_u32 s63, s63, s70
  buffer_load_dwordx4 v183, s[32:35], s63 offen nt lds
  s_nop 0
  s_waitcnt vmcnt(8)
  v_mfma_f32_16x16x16_bf16 v[58:61], v[72:73], a[252:253], v[58:61]
  v_mfma_f32_16x16x16_bf16 v[62:65], v[72:73], a[254:255], v[62:65]
  s_nop 6
  ds_write_b128 v16, v[58:61] offset:55296
  ds_write_b128 v16, v[62:65] offset:55312
  s_mov_b64 exec, 0xffffffff
  s_waitcnt lgkmcnt(0)
  s_barrier
  ds_read_b128 v[42:45], v17 offset:55296
  ds_read_b128 v[46:49], v17 offset:57344
  ds_read_b128 v[50:53], v17 offset:59392
  ds_read_b128 v[54:57], v17 offset:61440
  s_waitcnt lgkmcnt(2)
  v_pk_add_f32 v[42:43], v[42:43], v[46:47]
  v_pk_add_f32 v[44:45], v[44:45], v[48:49]
  s_waitcnt lgkmcnt(0)
  v_pk_add_f32 v[50:51], v[50:51], v[54:55]
  v_pk_add_f32 v[52:53], v[52:53], v[56:57]
  v_pk_add_f32 v[42:43], v[42:43], v[50:51]
  v_pk_add_f32 v[44:45], v[44:45], v[52:53]
  buffer_store_dwordx4 v[42:45], v186, s[16:19], 0 offen sc1
  s_mov_b64 exec, -1
  s_mov_b32 s20, 0x80000
  s_mov_b32 s21, 0x82000
  s_mov_b32 s22, 0x84000
  s_mov_b32 s23, 0x86000
  s_mov_b32 s44, 0x88000
  s_mov_b32 s45, 0x8a000
  s_mov_b32 s46, 0x8c000
  s_mov_b32 s47, 0x8e000
  s_mov_b32 s7, 0
  buffer_load_dwordx4 v[138:141], v184, s[16:19], s20 offen sc1
  buffer_load_dwordx4 v[142:145], v184, s[16:19], s21 offen sc1
  buffer_load_dwordx4 v[146:149], v184, s[16:19], s22 offen sc1
  buffer_load_dwordx4 v[150:153], v184, s[16:19], s23 offen sc1
  buffer_load_dwordx4 v[154:157], v184, s[16:19], s44 offen sc1
  buffer_load_dwordx4 v[158:161], v184, s[16:19], s45 offen sc1
  buffer_load_dwordx4 v[162:165], v184, s[16:19], s46 offen sc1
  buffer_load_dwordx4 v[166:169], v184, s[16:19], s47 offen sc1
  s_waitcnt vmcnt(8)
  ds_read_b64_tr_b16 v[90:91], v9 offset:0
  ds_read_b64_tr_b16 v[92:93], v9 offset:2048
  ds_read_b64_tr_b16 v[94:95], v9 offset:256
  ds_read_b64_tr_b16 v[96:97], v9 offset:2304
  ds_read_b64_tr_b16 v[98:99], v9 offset:512
  ds_read_b64_tr_b16 v[100:101], v9 offset:2560
  ds_read_b64_tr_b16 v[102:103], v9 offset:768
  ds_read_b64_tr_b16 v[104:105], v9 offset:2816
  ds_read_b64_tr_b16 v[106:107], v9 offset:4096
  ds_read_b64_tr_b16 v[108:109], v9 offset:6144
  ds_read_b64_tr_b16 v[110:111], v9 offset:4352
  ds_read_b64_tr_b16 v[112:113], v9 offset:6400
  ds_read_b64_tr_b16 v[114:115], v9 offset:4608
  ds_read_b64_tr_b16 v[116:117], v9 offset:6656
  ds_read_b64_tr_b16 v[118:119], v9 offset:4864
  ds_read_b64_tr_b16 v[120:121], v9 offset:6912
  s_branch L_gather_13_w
L_gather_13:
  buffer_load_dwordx4 v[138:141], v184, s[16:19], s20 offen sc1
  buffer_load_dwordx4 v[142:145], v184, s[16:19], s21 offen sc1
  buffer_load_dwordx4 v[146:149], v184, s[16:19], s22 offen sc1
  buffer_load_dwordx4 v[150:153], v184, s[16:19], s23 offen sc1
  buffer_load_dwordx4 v[154:157], v184, s[16:19], s44 offen sc1
  buffer_load_dwordx4 v[158:161], v184, s[16:19], s45 offen sc1
  buffer_load_dwordx4 v[162:165], v184, s[16:19], s46 offen sc1
  buffer_load_dwordx4 v[166:169], v184, s[16:19], s47 offen sc1
L_gather_13_w:
  s_waitcnt vmcnt(0)
L_gather_13_c:
  v_max3_u32 v204, v138, v142, v146
  v_max3_u32 v204, v204, v150, v154
  v_max3_u32 v204, v204, v158, v162
  v_max_u32 v204, v204, v166
  v_cmp_eq_u32 vcc, -1, v204
  s_cbranch_vccz L_ok_15
L_retry_14:
  v_cmp_eq_u32 s[8:9], -1, v138
  v_cmp_eq_u32 s[10:11], -1, v142
  v_cmp_eq_u32 s[12:13], -1, v146
  v_cmp_eq_u32 s[14:15], -1, v150
  v_cmp_eq_u32 s[24:25], -1, v154
  v_cmp_eq_u32 s[26:27], -1, v158
  v_cmp_eq_u32 s[48:49], -1, v162
  v_cmp_eq_u32 s[50:51], -1, v166
  s_mov_b64 exec, s[8:9]
  buffer_load_dwordx4 v[138:141], v184, s[16:19], s20 offen sc1
  s_mov_b64 exec, s[10:11]
  buffer_load_dwordx4 v[142:145], v184, s[16:19], s21 offen sc1
  s_mov_b64 exec, s[12:13]
  buffer_load_dwordx4 v[146:149], v184, s[16:19], s22 offen sc1
  s_mov_b64 exec, s[14:15]
  buffer_load_dwordx4 v[150:153], v184, s[16:19], s23 offen sc1
  s_mov_b64 exec, s[24:25]
  buffer_load_dwordx4 v[154:157], v184, s[16:19], s44 offen sc1
  s_mov_b64 exec, s[26:27]
  buffer_load_dwordx4 v[158:161], v184, s[16:19], s45 offen sc1
  s_mov_b64 exec, s[48:49]
  buffer_load_dwordx4 v[162:165], v184, s[16:19], s46 offen sc1
  s_mov_b64 exec, s[50:51]
  buffer_load_dwordx4 v[166:169], v184, s[16:19], s47 offen sc1
  s_mov_b64 exec, -1
  s_add_u32 s7, s7, 1
  s_cmp_ge_u32 s7, 65536
  s_waitcnt vmcnt(0)
  s_cbranch_scc1 L_ok_15
  v_max3_u32 v204, v138, v142, v146
  v_max3_u32 v204, v204, v150, v154
  v_max3_u32 v204, v204, v158, v162
  v_max_u32 v204, v204, v166
  v_cmp_eq_u32 vcc, -1, v204
  s_cbranch_vccz L_ok_15
  s_branch L_retry_14
L_ok_15:
  v_pk_add_f32 v[138:139], v[138:139], v[142:143]
  v_pk_add_f32 v[140:141], v[140:141], v[144:145]
  v_pk_add_f32 v[146:147], v[146:147], v[150:151]
  v_pk_add_f32 v[148:149], v[148:149], v[152:153]
  v_pk_add_f32 v[154:155], v[154:155], v[158:159]
  v_pk_add_f32 v[156:157], v[156:157], v[160:161]
  v_pk_add_f32 v[162:163], v[162:163], v[166:167]
  v_pk_add_f32 v[164:165], v[164:165], v[168:169]
  v_pk_add_f32 v[138:139], v[138:139], v[146:147]
  v_pk_add_f32 v[140:141], v[140:141], v[148:149]
  v_pk_add_f32 v[154:155], v[154:155], v[162:163]
  v_pk_add_f32 v[156:157], v[156:157], v[164:165]
  v_pk_add_f32 v[138:139], v[138:139], v[154:155]
  v_pk_add_f32 v[140:141], v[140:141], v[156:157]
  v_cvt_pk_bf16_f32 v10, v138, v139
  v_cvt_pk_bf16_f32 v11, v140, v141
  ds_write_b64 v180, v[10:11] offset:32768
  ds_read2_b64 v[74:77], v181 offset0:0 offset1:4
  ds_read2_b64 v[78:81], v181 offset0:8 offset1:12
  v_cmp_u_f32 vcc, v138, v139
  v_cmp_u_f32 s[8:9], v140, v141
  s_add_u32 s7, s7, 1
  s_cmp_ge_u32 s7, 65536
  s_cbranch_scc1 L_done_16
  s_or_b64 vcc, vcc, s[8:9]
  s_cbranch_scc1 L_gather_13
L_done_16:
  s_waitcnt lgkmcnt(1)
  v_mfma_f32_16x16x32_bf16 v[42:45], v[74:77], v[90:93], 0
  v_mfma_f32_16x16x32_bf16 v[46:49], v[74:77], v[94:97], 0
  v_mfma_f32_16x16x32_bf16 v[50:53], v[74:77], v[98:101], 0
  v_mfma_f32_16x16x32_bf16 v[54:57], v[74:77], v[102:105], 0
  s_waitcnt lgkmcnt(0)
  v_mfma_f32_16x16x32_bf16 v[42:45], v[78:81], v[106:109], v[42:45]
  v_mfma_f32_16x16x32_bf16 v[46:49], v[78:81], v[110:113], v[46:49]
  v_mfma_f32_16x16x32_bf16 v[50:53], v[78:81], v[114:117], v[50:53]
  v_mfma_f32_16x16x32_bf16 v[54:57], v[78:81], v[118:121], v[54:57]
  s_nop 4
  v_pk_add_f32 v[42:43], v[42:43], v[44:45]
  v_pk_add_f32 v[46:47], v[46:47], v[48:49]
  v_pk_add_f32 v[50:51], v[50:51], v[52:53]
  v_pk_add_f32 v[54:55], v[54:55], v[56:57]
  v_add_f32 v42, v42, v43
  v_add_f32 v46, v46, v47
  v_add_f32 v50, v50, v51
  v_add_f32 v54, v54, v55
  v_cndmask_b32_e64 v6, v42, v46, s[58:59]
  v_cndmask_b32_e64 v7, v50, v54, s[58:59]
  v_cndmask_b32_e64 v6, v6, v7, s[60:61]
  ds_write_b32 v182, v6 offset:53248
  s_cmp_lg_u32 s3, 0
  s_waitcnt lgkmcnt(0)
  s_barrier
  s_cbranch_scc1 L_bdone_17
  ds_read_b128 v[42:45], v187 offset:53248
  s_waitcnt lgkmcnt(0)
  v_add_f32 v42, v42, v43
  v_add_f32 v44, v44, v45
  v_add_f32 v42, v42, v44
  buffer_store_dword v42, v185, s[16:19], 0 offen sc1
L_bdone_17:
  s_endpgm
L_roleC:
  v_lshrrev_b32 v8, 4, v1
  v_and_b32 v10, 15, v1
  s_lshl_b32 s62, s66, 14
  s_lshl_b32 s63, s3, 8
  s_add_u32 s62, s62, s63
  v_lshlrev_b32 v6, 12, v8
  v_lshl_add_u32 v6, v10, 4, v6
  v_add_u32 v185, s62, v6
  s_lshl_b32 s62, s3, 11
  v_lshl_add_u32 v16, v1, 5, s62
  s_lshl_b32 s62, s3, 9
  v_and_b32 v17, 31, v1
  v_lshl_add_u32 v17, v17, 4, s62
  v_and_b32_dpp v70, v40, v4 quad_perm:[2,2,2,2] row_mask:0xf bank_mask:0xf
  v_and_b32_dpp v71, v40, v5 quad_perm:[2,2,2,2] row_mask:0xf bank_mask:0xf
  s_waitcnt vmcnt(6)
  v_mfma_f32_16x16x16_bf16 v[58:61], v[68:69], a[228:229], v[58:61]
  v_mfma_f32_16x16x16_bf16 v[62:65], v[68:69], a[230:231], v[62:65]
  buffer_load_dwordx4 v[122:125], v185, s[36:39], 0 offen offset:0 nt
  v_and_b32_dpp v72, v40, v4 quad_perm:[3,3,3,3] row_mask:0xf bank_mask:0xf
  v_and_b32_dpp v73, v40, v5 quad_perm:[3,3,3,3] row_mask:0xf bank_mask:0xf
  s_waitcnt vmcnt(6)
  v_mfma_f32_16x16x16_bf16 v[58:61], v[70:71], a[232:233], v[58:61]
  v_mfma_f32_16x16x16_bf16 v[62:65], v[70:71], a[234:235], v[62:65]
  buffer_load_dwordx4 v[126:129], v185, s[36:39], 0 offen offset:1024 nt
  v_and_b32_dpp v66, v41, v4 quad_perm:[0,0,0,0] row_mask:0xf bank_mask:0xf
  v_and_b32_dpp v67, v41, v5 quad_perm:[0,0,0,0] row_mask:0xf bank_mask:0xf
  s_waitcnt vmcnt(6)
  v_mfma_f32_16x16x16_bf16 v[58:61], v[72:73], a[236:237], v[58:61]
  v_mfma_f32_16x16x16_bf16 v[62:65], v[72:73], a[238:239], v[62:65]
  buffer_load_dwordx4 v[130:133], v185, s[36:39], 0 offen offset:2048 nt
  v_and_b32_dpp v68, v41, v4 quad_perm:[1,1,1,1] row_mask:0xf bank_mask:0xf
  v_and_b32_dpp v69, v41, v5 quad_perm:[1,1,1,1] row_mask:0xf bank_mask:0xf
  s_waitcnt vmcnt(6)
  v_mfma_f32_16x16x16_bf16 v[58:61], v[66:67], a[240:241], v[58:61]
  v_mfma_f32_16x16x16_bf16 v[62:65], v[66:67], a[242:243], v[62:65]
  buffer_load_dwordx4 v[134:137], v185, s[36:39], 0 offen offset:3072 nt
  v_and_b32_dpp v70, v41, v4 quad_perm:[2,2,2,2] row_mask:0xf bank_mask:0xf
  v_and_b32_dpp v71, v41, v5 quad_perm:[2,2,2,2] row_mask:0xf bank_mask:0xf
  s_waitcnt vmcnt(6)
  v_mfma_f32_16x16x16_bf16 v[58:61], v[68:69], a[244:245], v[58:61]
  v_mfma_f32_16x16x16_bf16 v[62:65], v[68:69], a[246:247], v[62:65]
  v_and_b32_dpp v72, v41, v4 quad_perm:[3,3,3,3] row_mask:0xf bank_mask:0xf
  v_and_b32_dpp v73, v41, v5 quad_perm:[3,3,3,3] row_mask:0xf bank_mask:0xf
  s_waitcnt vmcnt(5)
  v_mfma_f32_16x16x16_bf16 v[58:61], v[70:71], a[248:249], v[58:61]
  v_mfma_f32_16x16x16_bf16 v[62:65], v[70:71], a[250:251], v[62:65]
  s_nop 0
  s_waitcnt vmcnt(4)
  v_mfma_f32_16x16x16_bf16 v[58:61], v[72:73], a[252:253], v[58:61]
  v_mfma_f32_16x16x16_bf16 v[62:65], v[72:73], a[254:255], v[62:65]
  s_nop 6
  ds_write_b128 v16, v[58:61] offset:55296
  ds_write_b128 v16, v[62:65] offset:55312
  s_mov_b64 exec, 0xffffffff
  s_waitcnt lgkmcnt(0)
  s_barrier
  ds_read_b128 v[42:45], v17 offset:55296
  ds_read_b128 v[46:49], v17 offset:57344
  ds_read_b128 v[50:53], v17 offset:59392
  ds_read_b128 v[54:57], v17 offset:61440
  s_waitcnt lgkmcnt(2)
  v_pk_add_f32 v[42:43], v[42:43], v[46:47]
  v_pk_add_f32 v[44:45], v[44:45], v[48:49]
  s_waitcnt lgkmcnt(0)
  v_pk_add_f32 v[50:51], v[50:51], v[54:55]
  v_pk_add_f32 v[52:53], v[52:53], v[56:57]
  v_pk_add_f32 v[42:43], v[42:43], v[50:51]
  v_pk_add_f32 v[44:45], v[44:45], v[52:53]
  buffer_store_dwordx4 v[42:45], v186, s[16:19], 0 offen sc1
  s_mov_b64 exec, -1
  s_cmp_lt_u32 s3, 2
  s_cselect_b64 s[72:73], s[50:51], s[52:53]
  s_mov_b32 s74, 1835008
  s_mov_b32 s75, 0x20000
  s_lshl_b32 s62, s5, 1
  s_and_b32 s63, s3, 1
  s_add_u32 s62, s62, s63
  s_mul_i32 s62, s62, 28672
  s_lshr_b32 s63, s4, 1
  s_mul_i32 s63, s63, 896
  s_add_u32 s62, s62, s63
  v_lshrrev_b32 v6, 3, v1
  v_mul_u32_u24 v6, 3584, v6
  v_and_b32 v7, 7, v1
  v_lshl_add_u32 v6, v7, 7, v6
  s_mov_b32 exec_lo, 0x7f7f7f7f
  s_mov_b32 exec_hi, 0x7f7f7f7f
  buffer_load_dword v190, v6, s[72:75], s62 offen
  s_mov_b64 exec, -1
  s_lshl_b32 s62, s3, 13
  s_add_u32 m0, s62, 0
  s_mul_i32 s63, s69, 0
  buffer_load_dwordx4 v183, s[28:31], s63 offen nt lds
  s_lshl_b32 s62, s3, 13
  s_add_u32 m0, s62, 1024
  s_mul_i32 s63, s69, 1
  buffer_load_dwordx4 v183, s[28:31], s63 offen nt lds
  s_lshl_b32 s62, s3, 13
  s_add_u32 m0, s62, 2048
  s_mul_i32 s63, s69, 2
  buffer_load_dwordx4 v183, s[28:31], s63 offen nt lds
  s_lshl_b32 s62, s3, 13
  s_add_u32 m0, s62, 3072
  s_mul_i32 s63, s69, 3
  buffer_load_dwordx4 v183, s[28:31], s63 offen nt lds
  s_lshl_b32 s62, s3, 13
  s_add_u32 m0, s62, 4096
  s_mul_i32 s63, s69, 0
  s_add_u32 s63, s63, s70
  buffer_load_dwordx4 v183, s[32:35], s63 offen nt lds
  s_lshl_b32 s62, s3, 13
  s_add_u32 m0, s62, 5120
  s_mul_i32 s63, s69, 1
  s_add_u32 s63, s63, s70
  buffer_load_dwordx4 v183, s[32:35], s63 offen nt lds
  s_lshl_b32 s62, s3, 13
  s_add_u32 m0, s62, 6144
  s_mul_i32 s63, s69, 2
  s_add_u32 s63, s63, s70
  buffer_load_dwordx4 v183, s[32:35], s63 offen nt lds
  s_lshl_b32 s62, s3, 13
  s_add_u32 m0, s62, 7168
  s_mul_i32 s63, s69, 3
  s_add_u32 s63, s63, s70
  buffer_load_dwordx4 v183, s[32:35], s63 offen nt lds
  v_and_b32 v6, 4, v1
  v_cmp_ne_u32 vcc, 0, v6
  s_lshl_b32 s62, s3, 13
  v_lshl_add_u32 v9, v1, 3, s62
  v_cndmask_b32_e64 v174, v4, 0, vcc
  v_cndmask_b32_e64 v175, v5, 0, vcc
  v_cndmask_b32_e64 v176, 0, v4, vcc
  v_cndmask_b32_e64 v177, 0, v5, vcc
  s_lshl_b32 s62, s3, 8
  s_add_u32 s62, s62, 50176
  v_lshl_add_u32 v181, v8, 3, s62
  v_mov_b32 v6, 54272
  v_cndmask_b32_e64 v181, v181, v6, s[54:55]
  v_and_b32 v6, 31, v1
  s_lshl_b32 s62, s3, 2
  v_lshl_add_u32 v182, v6, 4, s62
  v_and_b32 v7, 3, v1
  v_lshl_add_u32 v6, v8, 2, v7
  v_lshlrev_b32 v187, 4, v6
  s_lshl_b32 s62, s66, 11
  s_lshl_b32 s63, s3, 9
  s_add_u32 s62, s62, s63
  s_add_u32 s62, s62, 0x20000
  v_bfe_u32 v7, v1, 4, 1
  v_lshlrev_b32 v6, 5, v10
  v_lshl_add_u32 v6, v7, 4, v6
  v_add_u32 v180, s62, v6
  s_lshl_b32 s62, s3, 2
  s_add_u32 s62, s62, 54848
  v_mov_b32 v178, s62
  v_mov_b32 v183, 54848
  s_lshl_b32 s62, s3, 9
  s_add_u32 s62, s62, 55296
  v_lshl_add_u32 v6, v1, 2, s62
  v_cmp_eq_u32 vcc, 0, v1
  s_nop 1
  v_cndmask_b32 v178, v6, v178, vcc
  s_waitcnt vmcnt(0)
  ds_read_b64_tr_b16 v[90:91], v9 offset:0
  ds_read_b64_tr_b16 v[92:93], v9 offset:512
  ds_read_b64_tr_b16 v[94:95], v9 offset:1024
  ds_read_b64_tr_b16 v[96:97], v9 offset:1536
  ds_read_b64_tr_b16 v[98:99], v9 offset:2048
  ds_read_b64_tr_b16 v[100:101], v9 offset:2560
  ds_read_b64_tr_b16 v[102:103], v9 offset:3072
  ds_read_b64_tr_b16 v[104:105], v9 offset:3584
  ds_read_b64_tr_b16 v[106:107], v9 offset:4096
  ds_read_b64_tr_b16 v[108:109], v9 offset:4608
  ds_read_b64_tr_b16 v[110:111], v9 offset:5120
  ds_read_b64_tr_b16 v[112:113], v9 offset:5632
  ds_read_b64_tr_b16 v[114:115], v9 offset:6144
  ds_read_b64_tr_b16 v[116:117], v9 offset:6656
  ds_read_b64_tr_b16 v[118:119], v9 offset:7168
  ds_read_b64_tr_b16 v[120:121], v9 offset:7680
  s_mov_b32 s20, 0x4000
  s_mov_b32 s21, 0x5000
  s_mov_b32 s22, 0x6000
  s_mov_b32 s23, 0x7000
  s_mov_b32 s44, 0x8000
  s_mov_b32 s45, 0x9000
  s_mov_b32 s46, 0xa000
  s_mov_b32 s47, 0xb000
  s_mov_b32 s7, 0
L_gather_18:
  buffer_load_dwordx4 v[138:141], v184, s[16:19], s20 offen sc1
  buffer_load_dwordx4 v[142:145], v184, s[16:19], s21 offen sc1
  buffer_load_dwordx4 v[146:149], v184, s[16:19], s22 offen sc1
  buffer_load_dwordx4 v[150:153], v184, s[16:19], s23 offen sc1
  buffer_load_dwordx4 v[154:157], v184, s[16:19], s44 offen sc1
  buffer_load_dwordx4 v[158:161], v184, s[16:19], s45 offen sc1
  buffer_load_dwordx4 v[162:165], v184, s[16:19], s46 offen sc1
  buffer_load_dwordx4 v[166:169], v184, s[16:19], s47 offen sc1
L_gather_18_w:
  s_waitcnt vmcnt(0)
L_gather_18_c:
  v_max3_u32 v204, v138, v142, v146
  v_max3_u32 v204, v204, v150, v154
  v_max3_u32 v204, v204, v158, v162
  v_max_u32 v204, v204, v166
  v_cmp_eq_u32 vcc, -1, v204
  s_cbranch_vccz L_ok_20
L_retry_19:
  v_cmp_eq_u32 s[8:9], -1, v138
  v_cmp_eq_u32 s[10:11], -1, v142
  v_cmp_eq_u32 s[12:13], -1, v146
  v_cmp_eq_u32 s[14:15], -1, v150
  v_cmp_eq_u32 s[24:25], -1, v154
  v_cmp_eq_u32 s[26:27], -1, v158
  v_cmp_eq_u32 s[48:49], -1, v162
  v_cmp_eq_u32 s[50:51], -1, v166
  s_mov_b64 exec, s[8:9]
  buffer_load_dwordx4 v[138:141], v184, s[16:19], s20 offen sc1
  s_mov_b64 exec, s[10:11]
  buffer_load_dwordx4 v[142:145], v184, s[16:19], s21 offen sc1
  s_mov_b64 exec, s[12:13]
  buffer_load_dwordx4 v[146:149], v184, s[16:19], s22 offen sc1
  s_mov_b64 exec, s[14:15]
  buffer_load_dwordx4 v[150:153], v184, s[16:19], s23 offen sc1
  s_mov_b64 exec, s[24:25]
  buffer_load_dwordx4 v[154:157], v184, s[16:19], s44 offen sc1
  s_mov_b64 exec, s[26:27]
  buffer_load_dwordx4 v[158:161], v184, s[16:19], s45 offen sc1
  s_mov_b64 exec, s[48:49]
  buffer_load_dwordx4 v[162:165], v184, s[16:19], s46 offen sc1
  s_mov_b64 exec, s[50:51]
  buffer_load_dwordx4 v[166:169], v184, s[16:19], s47 offen sc1
  s_mov_b64 exec, -1
  s_add_u32 s7, s7, 1
  s_cmp_ge_u32 s7, 65536
  s_waitcnt vmcnt(0)
  s_cbranch_scc1 L_ok_20
  v_max3_u32 v204, v138, v142, v146
  v_max3_u32 v204, v204, v150, v154
  v_max3_u32 v204, v204, v158, v162
  v_max_u32 v204, v204, v166
  v_cmp_eq_u32 vcc, -1, v204
  s_cbranch_vccz L_ok_20
  s_branch L_retry_19
L_ok_20:
  v_pk_add_f32 v[138:139], v[138:139], v[142:143]
  v_pk_add_f32 v[140:141], v[140:141], v[144:145]
  v_pk_add_f32 v[146:147], v[146:147], v[150:151]
  v_pk_add_f32 v[148:149], v[148:149], v[152:153]
  v_pk_add_f32 v[154:155], v[154:155], v[158:159]
  v_pk_add_f32 v[156:157], v[156:157], v[160:161]
  v_pk_add_f32 v[162:163], v[162:163], v[166:167]
  v_pk_add_f32 v[164:165], v[164:165], v[168:169]
  v_pk_add_f32 v[138:139], v[138:139], v[146:147]
  v_pk_add_f32 v[140:141], v[140:141], v[148:149]
  v_pk_add_f32 v[154:155], v[154:155], v[162:163]
  v_pk_add_f32 v[156:157], v[156:157], v[164:165]
  v_pk_add_f32 v[138:139], v[138:139], v[154:155]
  v_pk_add_f32 v[140:141], v[140:141], v[156:157]
  v_mov_b32 v142, v138
  v_mov_b32 v143, v139
  v_mov_b32 v144, v140
  v_mov_b32 v145, v141
  v_permlane32_swap_b32 v138, v142
  v_permlane32_swap_b32 v139, v143
  v_permlane32_swap_b32 v140, v144
  v_permlane32_swap_b32 v141, v145
  v_add_f32 v138, v138, v142
  v_add_f32 v139, v139, v143
  v_add_f32 v140, v140, v144
  v_add_f32 v141, v141, v145
  v_pk_add_f32 v[138:139], v[138:139], v[18:19]
  v_pk_add_f32 v[140:141], v[140:141], v[20:21]
  v_cvt_pk_bf16_f32 v10, v138, v139
  v_cvt_pk_bf16_f32 v11, v140, v141
  ds_write_b64 v179, v[10:11] offset:50176
  ds_read2_b64 v[74:77], v181 offset0:0 offset1:4
  ds_read2_b64 v[78:81], v181 offset0:8 offset1:12
  ds_read2_b64 v[82:85], v181 offset0:16 offset1:20
  ds_read2_b64 v[86:89], v181 offset0:24 offset1:28
  v_cmp_u_f32 vcc, v138, v139
  v_cmp_u_f32 s[8:9], v140, v141
  s_add_u32 s7, s7, 1
  s_cmp_ge_u32 s7, 65536
  s_cbranch_scc1 L_done_21
  s_or_b64 vcc, vcc, s[8:9]
  s_cbranch_scc1 L_gather_18
L_done_21:
  s_waitcnt lgkmcnt(3)
  v_mfma_f32_16x16x32_bf16 v[50:53], v[74:77], v[74:77], 0
  v_mfma_f32_16x16x32_bf16 v[42:45], v[74:77], v[90:93], 0
  v_mfma_f32_16x16x32_bf16 v[46:49], v[74:77], v[106:109], 0
  s_waitcnt lgkmcnt(2)
  v_mfma_f32_16x16x32_bf16 v[50:53], v[78:81], v[78:81], v[50:53]
  v_mfma_f32_16x16x32_bf16 v[42:45], v[78:81], v[94:97], v[42:45]
  v_mfma_f32_16x16x32_bf16 v[46:49], v[78:81], v[110:113], v[46:49]
  s_waitcnt lgkmcnt(1)
  v_mfma_f32_16x16x32_bf16 v[50:53], v[82:85], v[82:85], v[50:53]
  v_mfma_f32_16x16x32_bf16 v[42:45], v[82:85], v[98:101], v[42:45]
  v_mfma_f32_16x16x32_bf16 v[46:49], v[82:85], v[114:117], v[46:49]
  s_waitcnt lgkmcnt(0)
  v_mfma_f32_16x16x32_bf16 v[50:53], v[86:89], v[86:89], v[50:53]
  v_mfma_f32_16x16x32_bf16 v[42:45], v[86:89], v[102:105], v[42:45]
  v_mfma_f32_16x16x32_bf16 v[46:49], v[86:89], v[118:121], v[46:49]
  s_nop 5
  ds_write2_b32 v178, v51, v50 offset0:0 offset1:4
  s_nop 0
  v_cndmask_b32_e64 v6, v42, v46, s[58:59]
  v_cndmask_b32_e64 v7, v43, v47, s[58:59]
  ds_write2st64_b32 v182, v6, v7 offset0:208 offset1:210
  s_waitcnt lgkmcnt(0)
  s_barrier
  ds_read_b128 v[138:141], v183
  ds_read_b128 v[142:145], v183 offset:16
  ds_read_b128 v[42:45], v187 offset:53248
  ds_read_b128 v[46:49], v187 offset:53504
  ds_read_b128 v[50:53], v187 offset:53760
  ds_read_b128 v[54:57], v187 offset:54016
  s_waitcnt lgkmcnt(4)
  v_pk_add_f32 v[138:139], v[138:139], v[140:141]
  v_pk_add_f32 v[142:143], v[142:143], v[144:145]
  v_add_f32 v138, v138, v139
  v_add_f32 v142, v142, v143
  v_mul_f32 v138, 0x3b000000, v138
  v_mul_f32 v142, 0x3b000000, v142
  v_fma_f32 v142, -v138, v138, v142
  v_max_f32 v142, 0, v142
  v_add_f32 v142, 0x3727c5ac, v142
  v_rsq_f32 v142, v142
  s_waitcnt lgkmcnt(0)
  v_pk_add_f32 v[42:43], v[42:43], v[44:45]
  v_pk_add_f32 v[46:47], v[46:47], v[48:49]
  v_pk_add_f32 v[50:51], v[50:51], v[52:53]
  v_pk_add_f32 v[54:55], v[54:55], v[56:57]
  v_add_f32 v42, v42, v43
  v_add_f32 v46, v46, v47
  v_add_f32 v50, v50, v51
  v_add_f32 v54, v54, v55
  v_fma_f32 v42, -v138, v50, v42
  v_fma_f32 v46, -v138, v54, v46
  v_mul_f32 v8, s67, v142
  v_mul_f32 v7, v46, v142
  v_mul_f32 v6, v42, v8
  v_exp_f32 v6, -v6
  s_nop 0
  v_add_f32 v6, 1.0, v6
  v_rcp_f32 v6, v6
  s_nop 0
  v_mul_f32 v6, v6, v7
  v_cvt_pk_bf16_f32 v6, v6, v6
  s_nop 1
  v_and_b32_dpp v74, v6, v174 quad_perm:[0,0,0,0] row_mask:0xf bank_mask:0xf
  v_and_b32_dpp v75, v6, v175 quad_perm:[0,0,0,0] row_mask:0xf bank_mask:0xf
  v_and_b32_dpp v76, v6, v176 quad_perm:[0,0,0,0] row_mask:0xf bank_mask:0xf
  v_and_b32_dpp v77, v6, v177 quad_perm:[0,0,0,0] row_mask:0xf bank_mask:0xf
  v_and_b32_dpp v78, v6, v174 quad_perm:[1,1,1,1] row_mask:0xf bank_mask:0xf
  v_and_b32_dpp v79, v6, v175 quad_perm:[1,1,1,1] row_mask:0xf bank_mask:0xf
  v_and_b32_dpp v80, v6, v176 quad_perm:[1,1,1,1] row_mask:0xf bank_mask:0xf
  v_and_b32_dpp v81, v6, v177 quad_perm:[1,1,1,1] row_mask:0xf bank_mask:0xf
  v_mfma_f32_16x16x32_bf16 v[42:45], v[74:77], v[122:125], 0
  v_and_b32_dpp v82, v6, v174 quad_perm:[2,2,2,2] row_mask:0xf bank_mask:0xf
  v_and_b32_dpp v83, v6, v175 quad_perm:[2,2,2,2] row_mask:0xf bank_mask:0xf
  v_and_b32_dpp v84, v6, v176 quad_perm:[2,2,2,2] row_mask:0xf bank_mask:0xf
  v_and_b32_dpp v85, v6, v177 quad_perm:[2,2,2,2] row_mask:0xf bank_mask:0xf
  v_mfma_f32_16x16x32_bf16 v[42:45], v[78:81], v[126:129], v[42:45]
  v_and_b32_dpp v86, v6, v174 quad_perm:[3,3,3,3] row_mask:0xf bank_mask:0xf
  v_and_b32_dpp v87, v6, v175 quad_perm:[3,3,3,3] row_mask:0xf bank_mask:0xf
  v_and_b32_dpp v88, v6, v176 quad_perm:[3,3,3,3] row_mask:0xf bank_mask:0xf
  v_and_b32_dpp v89, v6, v177 quad_perm:[3,3,3,3] row_mask:0xf bank_mask:0xf
  v_mfma_f32_16x16x32_bf16 v[42:45], v[82:85], v[130:133], v[42:45]
  s_nop 0
  v_mfma_f32_16x16x32_bf16 v[42:45], v[86:89], v[134:137], v[42:45]
  s_nop 6
  s_mov_b64 exec, 0xffffffff
  buffer_store_dwordx4 v[42:45], v180, s[16:19], 0 offen sc1
  s_mov_b64 exec, -1
  s_cmp_lg_u32 s3, 0
  s_cbranch_scc1 L_nofinal_22
  s_mul_i32 s62, s66, 147
  s_lshr_b32 s62, s62, 10
  s_mul_i32 s63, s62, 7
  s_sub_u32 s63, s66, s63
  s_cmp_ge_u32 s63, 4
  s_cbranch_scc1 L_nofinal_22
  s_lshl_b32 s62, s62, 2
  s_add_u32 s66, s62, s63
  v_and_b32 v10, 1, v1
  s_lshl_b32 s62, s66, 4
  v_lshl_add_u32 v185, v10, 3, s62
  ds_read_b64 v[202:203], v185 offset:50176
  s_lshl_b32 s62, s66, 5
  v_lshrrev_b32 v6, 1, v1
  v_lshlrev_b32 v6, 11, v6
  v_lshl_add_u32 v6, v10, 4, v6
  v_add_u32 v183, s62, v6
  v_mov_b32 v6, 0x20000000
  v_cndmask_b32_e64 v182, v183, v6, s[60:61]
  s_waitcnt lgkmcnt(0)
  v_lshlrev_b32 v170, 16, v202
  v_and_b32 v171, 0xffff0000, v202
  v_lshlrev_b32 v172, 16, v203
  v_and_b32 v173, 0xffff0000, v203
  s_waitcnt vmcnt(0)
  s_mov_b32 s20, 0x20000
  s_mov_b32 s21, 0x30000
  s_mov_b32 s22, 0x40000
  s_mov_b32 s23, 0x50000
  s_mov_b32 s7, 0
L_gather_23:
  buffer_load_dwordx4 v[138:141], v183, s[16:19], s20 offen sc1
  buffer_load_dwordx4 v[142:145], v183, s[16:19], s21 offen sc1
  buffer_load_dwordx4 v[146:149], v183, s[16:19], s22 offen sc1
  buffer_load_dwordx4 v[150:153], v182, s[16:19], s23 offen sc1
L_gather_23_w:
  s_waitcnt vmcnt(0)
L_gather_23_c:
  v_max3_u32 v204, v138, v142, v146
  v_max_u32 v204, v204, v150
  v_cmp_eq_u32 vcc, -1, v204
  s_cbranch_vccz L_ok_25
L_retry_24:
  v_cmp_eq_u32 s[8:9], -1, v138
  v_cmp_eq_u32 s[10:11], -1, v142
  v_cmp_eq_u32 s[12:13], -1, v146
  v_cmp_eq_u32 s[14:15], -1, v150
  s_mov_b64 exec, s[8:9]
  buffer_load_dwordx4 v[138:141], v183, s[16:19], s20 offen sc1
  s_mov_b64 exec, s[10:11]
  buffer_load_dwordx4 v[142:145], v183, s[16:19], s21 offen sc1
  s_mov_b64 exec, s[12:13]
  buffer_load_dwordx4 v[146:149], v183, s[16:19], s22 offen sc1
  s_mov_b64 exec, s[14:15]
  buffer_load_dwordx4 v[150:153], v182, s[16:19], s23 offen sc1
  s_mov_b64 exec, -1
  s_add_u32 s7, s7, 1
  s_cmp_ge_u32 s7, 65536
  s_waitcnt vmcnt(0)
  s_cbranch_scc1 L_ok_25
  v_max3_u32 v204, v138, v142, v146
  v_max_u32 v204, v204, v150
  v_cmp_eq_u32 vcc, -1, v204
  s_cbranch_vccz L_ok_25
  s_branch L_retry_24
L_ok_25:
  v_pk_add_f32 v[138:139], v[138:139], v[142:143]
  v_pk_add_f32 v[140:141], v[140:141], v[144:145]
  v_pk_add_f32 v[146:147], v[146:147], v[150:151]
  v_pk_add_f32 v[148:149], v[148:149], v[152:153]
  v_pk_add_f32 v[138:139], v[138:139], v[146:147]
  v_pk_add_f32 v[140:141], v[140:141], v[148:149]
  s_nop 0
  v_add_f32_dpp v138, v138, v138 quad_perm:[2,3,0,1] row_mask:0xf bank_mask:0xf
  v_add_f32_dpp v139, v139, v139 quad_perm:[2,3,0,1] row_mask:0xf bank_mask:0xf
  v_add_f32_dpp v140, v140, v140 quad_perm:[2,3,0,1] row_mask:0xf bank_mask:0xf
  v_add_f32_dpp v141, v141, v141 quad_perm:[2,3,0,1] row_mask:0xf bank_mask:0xf
  v_add_f32_dpp v138, v138, v138 row_ror:4 row_mask:0xf bank_mask:0xf
  v_add_f32_dpp v139, v139, v139 row_ror:4 row_mask:0xf bank_mask:0xf
  v_add_f32_dpp v140, v140, v140 row_ror:4 row_mask:0xf bank_mask:0xf
  v_add_f32_dpp v141, v141, v141 row_ror:4 row_mask:0xf bank_mask:0xf
  v_add_f32_dpp v138, v138, v138 row_ror:8 row_mask:0xf bank_mask:0xf
  v_add_f32_dpp v139, v139, v139 row_ror:8 row_mask:0xf bank_mask:0xf
  v_add_f32_dpp v140, v140, v140 row_ror:8 row_mask:0xf bank_mask:0xf
  v_add_f32_dpp v141, v141, v141 row_ror:8 row_mask:0xf bank_mask:0xf
  v_mov_b32 v142, v138
  v_mov_b32 v143, v139
  v_mov_b32 v144, v140
  v_mov_b32 v145, v141
  v_permlane16_swap_b32 v138, v142
  v_permlane16_swap_b32 v139, v143
  v_permlane16_swap_b32 v140, v144
  v_permlane16_swap_b32 v141, v145
  v_add_f32 v138, v138, v142
  v_add_f32 v139, v139, v143
  v_add_f32 v140, v140, v144
  v_add_f32 v141, v141, v145
  v_mov_b32 v142, v138
  v_mov_b32 v143, v139
  v_mov_b32 v144, v140
  v_mov_b32 v145, v141
  v_permlane32_swap_b32 v138, v142
  v_permlane32_swap_b32 v139, v143
  v_permlane32_swap_b32 v140, v144
  v_permlane32_swap_b32 v141, v145
  v_add_f32 v138, v138, v142
  v_add_f32 v139, v139, v143
  v_add_f32 v140, v140, v144
  v_add_f32 v141, v141, v145
  v_cmp_u_f32 vcc, v138, v139
  v_cmp_u_f32 s[8:9], v140, v141
  s_add_u32 s7, s7, 1
  s_cmp_ge_u32 s7, 65536
  s_cbranch_scc1 L_done_26
  s_or_b64 vcc, vcc, s[8:9]
  s_cbranch_scc1 L_gather_23
L_done_26:
  v_pk_add_f32 v[138:139], v[138:139], v[170:171]
  v_pk_add_f32 v[140:141], v[140:141], v[172:173]
  v_cvt_pk_bf16_f32 v10, v138, v139
  v_cvt_pk_bf16_f32 v11, v140, v141
  s_mov_b64 exec, 3
  buffer_store_dwordx2 v[10:11], v185, s[40:43], 0 offen
  s_mov_b64 exec, -1
L_nofinal_22:
  s_endpgm
L_roleD:
  s_lshl_b32 s62, s3, 11
  v_lshl_add_u32 v16, v1, 5, s62
  s_lshl_b32 s62, s3, 9
  v_and_b32 v17, 31, v1
  v_lshl_add_u32 v17, v17, 4, s62
  v_and_b32_dpp v70, v40, v4 quad_perm:[2,2,2,2] row_mask:0xf bank_mask:0xf
  v_and_b32_dpp v71, v40, v5 quad_perm:[2,2,2,2] row_mask:0xf bank_mask:0xf
  s_waitcnt vmcnt(6)
  v_mfma_f32_16x16x16_bf16 v[58:61], v[68:69], a[228:229], v[58:61]
  v_mfma_f32_16x16x16_bf16 v[62:65], v[68:69], a[230:231], v[62:65]
  v_and_b32_dpp v72, v40, v4 quad_perm:[3,3,3,3] row_mask:0xf bank_mask:0xf
  v_and_b32_dpp v73, v40, v5 quad_perm:[3,3,3,3] row_mask:0xf bank_mask:0xf
  s_waitcnt vmcnt(5)
  v_mfma_f32_16x16x16_bf16 v[58:61], v[70:71], a[232:233], v[58:61]
  v_mfma_f32_16x16x16_bf16 v[62:65], v[70:71], a[234:235], v[62:65]
  v_and_b32_dpp v66, v41, v4 quad_perm:[0,0,0,0] row_mask:0xf bank_mask:0xf
  v_and_b32_dpp v67, v41, v5 quad_perm:[0,0,0,0] row_mask:0xf bank_mask:0xf
  s_waitcnt vmcnt(4)
  v_mfma_f32_16x16x16_bf16 v[58:61], v[72:73], a[236:237], v[58:61]
  v_mfma_f32_16x16x16_bf16 v[62:65], v[72:73], a[238:239], v[62:65]
  v_and_b32_dpp v68, v41, v4 quad_perm:[1,1,1,1] row_mask:0xf bank_mask:0xf
  v_and_b32_dpp v69, v41, v5 quad_perm:[1,1,1,1] row_mask:0xf bank_mask:0xf
  s_waitcnt vmcnt(3)
  v_mfma_f32_16x16x16_bf16 v[58:61], v[66:67], a[240:241], v[58:61]
  v_mfma_f32_16x16x16_bf16 v[62:65], v[66:67], a[242:243], v[62:65]
  v_and_b32_dpp v70, v41, v4 quad_perm:[2,2,2,2] row_mask:0xf bank_mask:0xf
  v_and_b32_dpp v71, v41, v5 quad_perm:[2,2,2,2] row_mask:0xf bank_mask:0xf
  s_waitcnt vmcnt(2)
  v_mfma_f32_16x16x16_bf16 v[58:61], v[68:69], a[244:245], v[58:61]
  v_mfma_f32_16x16x16_bf16 v[62:65], v[68:69], a[246:247], v[62:65]
  v_and_b32_dpp v72, v41, v4 quad_perm:[3,3,3,3] row_mask:0xf bank_mask:0xf
  v_and_b32_dpp v73, v41, v5 quad_perm:[3,3,3,3] row_mask:0xf bank_mask:0xf
  s_waitcnt vmcnt(1)
  v_mfma_f32_16x16x16_bf16 v[58:61], v[70:71], a[248:249], v[58:61]
  v_mfma_f32_16x16x16_bf16 v[62:65], v[70:71], a[250:251], v[62:65]
  s_nop 0
  s_waitcnt vmcnt(0)
  v_mfma_f32_16x16x16_bf16 v[58:61], v[72:73], a[252:253], v[58:61]
  v_mfma_f32_16x16x16_bf16 v[62:65], v[72:73], a[254:255], v[62:65]
  s_nop 6
  ds_write_b128 v16, v[58:61] offset:55296
  ds_write_b128 v16, v[62:65] offset:55312
  s_mov_b64 exec, 0xffffffff
  s_waitcnt lgkmcnt(0)
  s_barrier
  ds_read_b128 v[42:45], v17 offset:55296
  ds_read_b128 v[46:49], v17 offset:57344
  ds_read_b128 v[50:53], v17 offset:59392
  ds_read_b128 v[54:57], v17 offset:61440
  s_waitcnt lgkmcnt(2)
  v_pk_add_f32 v[42:43], v[42:43], v[46:47]
  v_pk_add_f32 v[44:45], v[44:45], v[48:49]
  s_waitcnt lgkmcnt(0)
  v_pk_add_f32 v[50:51], v[50:51], v[54:55]
  v_pk_add_f32 v[52:53], v[52:53], v[56:57]
  v_pk_add_f32 v[42:43], v[42:43], v[50:51]
  v_pk_add_f32 v[44:45], v[44:45], v[52:53]
  buffer_store_dwordx4 v[42:45], v186, s[16:19], 0 offen sc1
  s_mov_b64 exec, -1
  s_cmp_lt_u32 s3, 2
  s_cselect_b64 s[72:73], s[50:51], s[52:53]
  s_mov_b32 s74, 1835008
  s_mov_b32 s75, 0x20000
  s_lshl_b32 s62, s5, 1
  s_and_b32 s63, s3, 1
  s_add_u32 s62, s62, s63
  s_mul_i32 s62, s62, 28672
  s_lshr_b32 s63, s4, 1
  s_mul_i32 s63, s63, 896
  s_add_u32 s62, s62, s63
  v_lshrrev_b32 v6, 3, v1
  v_mul_u32_u24 v6, 3584, v6
  v_and_b32 v7, 7, v1
  v_lshl_add_u32 v6, v7, 7, v6
  s_mov_b32 exec_lo, 0x7f7f7f7f
  s_mov_b32 exec_hi, 0x7f7f7f7f
  buffer_load_dword v190, v6, s[72:75], s62 offen
  s_mov_b64 exec, -1
L_fin:
  s_endpgm
L_end:
  s_endpgm
.section .rodata,"a"
.p2align 6
.amdhsa_kernel sequential_preLN__gqa_block_cached__glu_gated_glu__decode_kernel
  .amdhsa_next_free_vgpr 512
  .amdhsa_next_free_sgpr 102
  .amdhsa_accum_offset 256
  .amdhsa_group_segment_fixed_size 0
  .amdhsa_kernarg_size 96
  .amdhsa_user_sgpr_count 2
  .amdhsa_user_sgpr_kernarg_segment_ptr 1
  .amdhsa_system_sgpr_workgroup_id_x 1
  .amdhsa_float_denorm_mode_32 3
.end_amdhsa_kernel
```
